```python
import torch

def _softmax(x, axis=-1):
    return torch.softmax(x, dim=axis)

def _gelu(x):
    return torch.nn.functional.gelu(x, approximate='tanh')

def _silu(x):
    return torch.nn.functional.silu(x)

def _sigmoid(x):
    return torch.sigmoid(x)

def _layernorm(x, axis=-1, eps=1e-05):
    m = x.mean(dim=axis, keepdim=True)
    v = x.var(dim=axis, keepdim=True, unbiased=False)
    return (x - m) / torch.sqrt(v + eps)

def _scatter_add(tgt, idx, src, axis=0):
    return tgt.clone().index_add_(axis, idx, src)

def _segment_sum(src, seg, n):
    out = torch.zeros((n,) + src.shape[1:], dtype=src.dtype)
    return out.index_add_(0, seg, src)

def _pad(x, pw):
    flat = tuple((v for pair in reversed(pw) for v in pair))
    return torch.nn.functional.pad(x, flat)
kernel_name = 'adaLN_cond__mha_block__glu_gated_geglu__prompt'

def setup_inputs():

    _w = lambda a: (lambda t: t.to(torch.bfloat16) if t.is_floating_point() else t)(torch.as_tensor(a))

    def _A_setup():
        B, S, D, H = (1, 2048, 448, 16)
        return {'x': _w((lambda *s: torch.randn(*s, dtype=torch.bfloat16) * 0.05)(B, S, D)), 'wqkv': _w((lambda *s: torch.randn(*s, dtype=torch.bfloat16) * 0.05)(D, 3 * D)), 'wo': _w((lambda *s: torch.randn(*s, dtype=torch.bfloat16) * 0.05)(D, D))}
    _A_in = _A_setup()

    def _B_setup():
        B, S, Dm, Df = (1, 2048, 448, 1792)
        return {'x': _w((lambda *s: torch.randn(*s, dtype=torch.bfloat16) * 0.05)(B, S, Dm)), 'w_gate': _w((lambda *s: torch.randn(*s, dtype=torch.bfloat16) * 0.8)(Dm, Df) * Dm ** (-0.5)), 'w_up': _w((lambda *s: torch.randn(*s, dtype=torch.bfloat16) * 0.8)(Dm, Df) * Dm ** (-0.5)), 'w_down': _w((lambda *s: torch.randn(*s, dtype=torch.bfloat16) * 0.8)(Df, Dm) * Df ** (-0.5))}
    _B_in = _B_setup()
    return {'A_x': _A_in['x'], 'A_wqkv': _A_in['wqkv'], 'A_wo': _A_in['wo'], 'B_x': _B_in['x'], 'B_w_gate': _B_in['w_gate'], 'B_w_up': _B_in['w_up'], 'B_w_down': _B_in['w_down'], 'c': _w((lambda *s: torch.randn(*s, dtype=torch.bfloat16) * 0.1)(1, 448) * 8.0), 'w_mod': _w((lambda *s: torch.randn(*s, dtype=torch.bfloat16) * 0.1)(448, 6 * 448) * 448 ** (-0.5) * 8.0)}

def reference(A_x, A_wqkv, A_wo, B_x, B_w_gate, B_w_up, B_w_down, c, w_mod):

    def _A_ref(x, wqkv, wo):
        B, S, D = x.shape
        H = 16
        Dh = D // H
        qkv = (lambda x, *d: x.permute(*d))((x @ wqkv).reshape(B, S, 3, H, Dh), 2, 0, 3, 1, 4)
        q, k, v = (qkv[0], qkv[1], qkv[2])
        scores = torch.einsum('bhqd,bhkd->bhqk', q, k) * Dh ** (-0.5)
        p = _softmax(scores, axis=-1)
        o = torch.einsum('bhqk,bhkd->bhqd', p, v)
        return (lambda x, *d: x.permute(*d))(o, 0, 2, 1, 3).reshape(B, S, D) @ wo

    def _B_ref(x, w_gate, w_up, w_down):
        g = torch.einsum('bsd,df->bsf', x, w_gate)
        u = torch.einsum('bsd,df->bsf', x, w_up)
        h = _gelu(g) * u
        return torch.einsum('bsf,fd->bsd', h, w_down)
    x = A_x
    mod = (_silu(c) @ w_mod).reshape(c.shape[0], 6, 1, -1)
    sa, ca, ga, sb, cb, gb = (mod[:, 0].clone(), mod[:, 1].clone(), mod[:, 2].clone(), mod[:, 3].clone(), mod[:, 4].clone(), mod[:, 5].clone())
    h = _layernorm(x, axis=-1) * (1 + ca) + sa
    x = x + ga * _A_ref(h, A_wqkv, A_wo)
    h = _layernorm(x, axis=-1) * (1 + cb) + sb
    x = x + gb * _B_ref(h, B_w_gate, B_w_up, B_w_down)
    return x
```

```asm
; @launch kernel=prep_kernel grid=(247,1,1) block=(512,1,1) lds=8192
; @launch kernel=mega_kernel grid=(256,1,1) block=(256,1,1) lds=163840
.amdgcn_target "amdgcn-amd-amdhsa--gfx950"
.text
.globl prep_kernel
.p2align 8
.type prep_kernel,@function
prep_kernel:
  s_cmp_ge_u32 s2, 247
  s_cbranch_scc1 P_exit
  s_load_dwordx4 s[4:7], s[0:1], 0
  s_load_dwordx2 s[36:37], s[0:1], 16
  s_load_dwordx2 s[56:57], s[0:1], 48
  s_load_dwordx4 s[60:63], s[0:1], 32
  s_load_dwordx4 s[28:31], s[0:1], 56
  s_load_dwordx2 s[32:33], s[0:1], 88
  s_getpc_b64 s[52:53]
  v_and_b32 v1, 63, v0
  v_lshrrev_b32 v2, 6, v0
  v_lshlrev_b32 v9, 7, v1
  s_mov_b32 s34, 0xffff0000
  v_readfirstlane_b32 s24, v2
  v_lshrrev_b32 v6, 5, v1
  v_and_b32 v13, 31, v1
  s_cmp_lg_u32 s24, 7
  s_cbranch_scc1 P_nowarm
  v_cmp_gt_u32 vcc, 40, v1
  s_nop 0
  s_and_saveexec_b64 s[54:55], vcc
  global_load_dword v100, v9, s[52:53]
  s_mov_b64 exec, s[54:55]
P_nowarm:
  s_waitcnt lgkmcnt(0)
  s_mov_b32 s20, s32
  s_mov_b32 s21, s33
  s_mov_b32 s22, 0x10000000
  s_mov_b32 s23, 0x20000
  s_cmp_ge_u32 s2, 112
  s_cbranch_scc1 P_other
  s_mov_b32 s8, s30
  s_mov_b32 s9, s31
  s_mov_b32 s10, 0x24c000
  s_mov_b32 s11, 0x20000
  s_mov_b32 s12, s28
  s_mov_b32 s13, s29
  s_mov_b32 s14, 0x380
  s_mov_b32 s15, 0x20000
  s_mov_b32 s16, s6
  s_mov_b32 s17, s7
  s_mov_b32 s18, 0x126000
  s_mov_b32 s19, 0x20000
  s_cmp_ge_u32 s2, 84
  s_cbranch_scc1 P_mod4
  s_cmp_ge_u32 s2, 42
  s_cselect_b32 s41, 42, 0
  s_cselect_b32 s39, 0, 1.0
  s_cselect_b32 s37, 0, 448
  s_sub_u32 s41, s2, s41
  s_mul_i32 s35, s41, 43691
  s_lshr_b32 s35, s35, 17
  s_mul_i32 s36, s35, 3
  s_sub_u32 s36, s41, s36
  s_lshr_b32 s42, s35, 1
  s_lshl_b32 s42, s42, 6
  s_add_u32 s37, s37, s42
  s_cmp_eq_u32 s36, 0
  s_cselect_b32 s40, 0x3e8b97f6, 1.0
  s_cmp_lt_u32 s24, 7
  s_cselect_b32 s46, 1, 0
  s_branch P_go
P_mod4:
  s_sub_u32 s41, s2, 84
  s_mul_i32 s35, s41, 9363
  s_lshr_b32 s35, s35, 16
  s_mul_i32 s36, s35, 7
  s_sub_u32 s36, s41, s36
  s_lshl_b32 s42, s35, 2
  s_lshr_b32 s37, 0x5243, s42
  s_and_b32 s37, s37, 15
  s_mul_i32 s37, s37, 448
  s_lshl_b32 s42, s36, 6
  s_add_u32 s37, s37, s42
  s_cmp_eq_u32 s35, 1
  s_cselect_b32 s39, 1.0, 0
  s_mov_b32 s40, 1.0
  s_mov_b32 s46, 0
P_go:
  s_mul_i32 s43, s24, 56
  v_add_u32 v3, s43, v1
  v_lshlrev_b32 v3, 1, v3
  buffer_load_ushort v7, v3, s[12:15], 0 offen
  v_mul_u32_u24 v8, 28, v6
  v_add_u32 v8, s43, v8
  s_movk_i32 s44, 5376
  v_mul_lo_u32 v12, v8, s44
  v_lshl_add_u32 v12, v13, 2, v12
  s_lshl_b32 s45, s37, 1
  buffer_load_dword v32, v12, s[8:11], s45 offen
  s_add_u32 s45, s45, s44
  buffer_load_dword v33, v12, s[8:11], s45 offen
  s_add_u32 s45, s45, s44
  buffer_load_dword v34, v12, s[8:11], s45 offen
  s_add_u32 s45, s45, s44
  buffer_load_dword v35, v12, s[8:11], s45 offen
  s_add_u32 s45, s45, s44
  buffer_load_dword v36, v12, s[8:11], s45 offen
  s_add_u32 s45, s45, s44
  buffer_load_dword v37, v12, s[8:11], s45 offen
  s_add_u32 s45, s45, s44
  buffer_load_dword v38, v12, s[8:11], s45 offen
  s_add_u32 s45, s45, s44
  buffer_load_dword v39, v12, s[8:11], s45 offen
  s_add_u32 s45, s45, s44
  buffer_load_dword v40, v12, s[8:11], s45 offen
  s_add_u32 s45, s45, s44
  buffer_load_dword v41, v12, s[8:11], s45 offen
  s_add_u32 s45, s45, s44
  buffer_load_dword v42, v12, s[8:11], s45 offen
  s_add_u32 s45, s45, s44
  buffer_load_dword v43, v12, s[8:11], s45 offen
  s_add_u32 s45, s45, s44
  buffer_load_dword v44, v12, s[8:11], s45 offen
  s_add_u32 s45, s45, s44
  buffer_load_dword v45, v12, s[8:11], s45 offen
  s_add_u32 s45, s45, s44
  buffer_load_dword v46, v12, s[8:11], s45 offen
  s_add_u32 s45, s45, s44
  buffer_load_dword v47, v12, s[8:11], s45 offen
  s_add_u32 s45, s45, s44
  buffer_load_dword v48, v12, s[8:11], s45 offen
  s_add_u32 s45, s45, s44
  buffer_load_dword v49, v12, s[8:11], s45 offen
  s_add_u32 s45, s45, s44
  buffer_load_dword v50, v12, s[8:11], s45 offen
  s_add_u32 s45, s45, s44
  buffer_load_dword v51, v12, s[8:11], s45 offen
  s_add_u32 s45, s45, s44
  buffer_load_dword v52, v12, s[8:11], s45 offen
  s_add_u32 s45, s45, s44
  buffer_load_dword v53, v12, s[8:11], s45 offen
  s_add_u32 s45, s45, s44
  buffer_load_dword v54, v12, s[8:11], s45 offen
  s_add_u32 s45, s45, s44
  buffer_load_dword v55, v12, s[8:11], s45 offen
  s_add_u32 s45, s45, s44
  buffer_load_dword v56, v12, s[8:11], s45 offen
  s_add_u32 s45, s45, s44
  buffer_load_dword v57, v12, s[8:11], s45 offen
  s_add_u32 s45, s45, s44
  buffer_load_dword v58, v12, s[8:11], s45 offen
  s_add_u32 s45, s45, s44
  buffer_load_dword v59, v12, s[8:11], s45 offen
  s_lshl_b32 s47, s24, 6
  v_lshl_add_u32 v14, v13, 1, s47
  s_mul_i32 s48, s36, 448
  s_lshl_b32 s42, s35, 5
  v_lshl_add_u32 v15, v6, 4, s42
  s_movk_i32 s49, 2688
  v_mul_lo_u32 v16, v15, s49
  v_add_u32 v17, s48, v14
  v_lshl_add_u32 v16, v17, 1, v16
  s_barrier
  s_cmp_eq_u32 s46, 0
  s_cbranch_scc1 P_notask1
  s_mov_b32 s45, 0
  buffer_load_dword v64, v16, s[16:19], s45 offen
  s_add_u32 s45, s45, s49
  buffer_load_dword v65, v16, s[16:19], s45 offen
  s_add_u32 s45, s45, s49
  buffer_load_dword v66, v16, s[16:19], s45 offen
  s_add_u32 s45, s45, s49
  buffer_load_dword v67, v16, s[16:19], s45 offen
  s_add_u32 s45, s45, s49
  buffer_load_dword v68, v16, s[16:19], s45 offen
  s_add_u32 s45, s45, s49
  buffer_load_dword v69, v16, s[16:19], s45 offen
  s_add_u32 s45, s45, s49
  buffer_load_dword v70, v16, s[16:19], s45 offen
  s_add_u32 s45, s45, s49
  buffer_load_dword v71, v16, s[16:19], s45 offen
  s_add_u32 s45, s45, s49
  buffer_load_dword v72, v16, s[16:19], s45 offen
  s_add_u32 s45, s45, s49
  buffer_load_dword v73, v16, s[16:19], s45 offen
  s_add_u32 s45, s45, s49
  buffer_load_dword v74, v16, s[16:19], s45 offen
  s_add_u32 s45, s45, s49
  buffer_load_dword v75, v16, s[16:19], s45 offen
  s_add_u32 s45, s45, s49
  buffer_load_dword v76, v16, s[16:19], s45 offen
  s_add_u32 s45, s45, s49
  buffer_load_dword v77, v16, s[16:19], s45 offen
  s_add_u32 s45, s45, s49
  buffer_load_dword v78, v16, s[16:19], s45 offen
  s_add_u32 s45, s45, s49
  buffer_load_dword v79, v16, s[16:19], s45 offen
  s_waitcnt vmcnt(44)
  s_branch P_c
P_notask1:
  s_waitcnt vmcnt(28)
P_c:
  v_lshlrev_b32 v7, 16, v7
  v_mul_f32 v18, 0xbfb8aa3b, v7
  v_exp_f32 v18, v18
  s_lshl_b32 s45, s24, 8
  v_lshl_add_u32 v19, v1, 2, s45
  v_add_f32 v18, 1.0, v18
  v_rcp_f32 v18, v18
  v_mul_u32_u24 v3, 112, v6
  v_add_u32 v3, s45, v3
  v_mul_f32 v7, v7, v18
  v_cvt_pk_bf16_f32 v7, v7, v7
  v_and_b32 v7, s34, v7
  ds_write_b32 v19, v7
  s_waitcnt lgkmcnt(0)
  ds_read_b128 v[96:99], v3 offset:0
  ds_read_b128 v[100:103], v3 offset:16
  ds_read_b128 v[104:107], v3 offset:32
  ds_read_b128 v[108:111], v3 offset:48
  ds_read_b128 v[112:115], v3 offset:64
  ds_read_b128 v[116:119], v3 offset:80
  ds_read_b128 v[120:123], v3 offset:96
  v_mov_b32 v20, 0
  v_mov_b32 v21, 0
  v_mov_b32 v22, 0
  v_mov_b32 v23, 0
  s_cmp_eq_u32 s46, 0
  s_cbranch_scc1 P_w0
  s_waitcnt vmcnt(16) lgkmcnt(0)
  s_branch P_w1
P_w0:
  s_waitcnt vmcnt(0) lgkmcnt(0)
P_w1:
  v_dot2c_f32_bf16 v21, v32, v96
  v_lshlrev_b32 v32, 16, v32
  v_fmac_f32 v20, v32, v96
  v_dot2c_f32_bf16 v23, v33, v97
  v_lshlrev_b32 v33, 16, v33
  v_fmac_f32 v22, v33, v97
  v_dot2c_f32_bf16 v21, v34, v98
  v_lshlrev_b32 v34, 16, v34
  v_fmac_f32 v20, v34, v98
  v_dot2c_f32_bf16 v23, v35, v99
  v_lshlrev_b32 v35, 16, v35
  v_fmac_f32 v22, v35, v99
  v_dot2c_f32_bf16 v21, v36, v100
  v_lshlrev_b32 v36, 16, v36
  v_fmac_f32 v20, v36, v100
  v_dot2c_f32_bf16 v23, v37, v101
  v_lshlrev_b32 v37, 16, v37
  v_fmac_f32 v22, v37, v101
  v_dot2c_f32_bf16 v21, v38, v102
  v_lshlrev_b32 v38, 16, v38
  v_fmac_f32 v20, v38, v102
  v_dot2c_f32_bf16 v23, v39, v103
  v_lshlrev_b32 v39, 16, v39
  v_fmac_f32 v22, v39, v103
  v_dot2c_f32_bf16 v21, v40, v104
  v_lshlrev_b32 v40, 16, v40
  v_fmac_f32 v20, v40, v104
  v_dot2c_f32_bf16 v23, v41, v105
  v_lshlrev_b32 v41, 16, v41
  v_fmac_f32 v22, v41, v105
  v_dot2c_f32_bf16 v21, v42, v106
  v_lshlrev_b32 v42, 16, v42
  v_fmac_f32 v20, v42, v106
  v_dot2c_f32_bf16 v23, v43, v107
  v_lshlrev_b32 v43, 16, v43
  v_fmac_f32 v22, v43, v107
  v_dot2c_f32_bf16 v21, v44, v108
  v_lshlrev_b32 v44, 16, v44
  v_fmac_f32 v20, v44, v108
  v_dot2c_f32_bf16 v23, v45, v109
  v_lshlrev_b32 v45, 16, v45
  v_fmac_f32 v22, v45, v109
  v_dot2c_f32_bf16 v21, v46, v110
  v_lshlrev_b32 v46, 16, v46
  v_fmac_f32 v20, v46, v110
  v_dot2c_f32_bf16 v23, v47, v111
  v_lshlrev_b32 v47, 16, v47
  v_fmac_f32 v22, v47, v111
  v_dot2c_f32_bf16 v21, v48, v112
  v_lshlrev_b32 v48, 16, v48
  v_fmac_f32 v20, v48, v112
  v_dot2c_f32_bf16 v23, v49, v113
  v_lshlrev_b32 v49, 16, v49
  v_fmac_f32 v22, v49, v113
  v_dot2c_f32_bf16 v21, v50, v114
  v_lshlrev_b32 v50, 16, v50
  v_fmac_f32 v20, v50, v114
  v_dot2c_f32_bf16 v23, v51, v115
  v_lshlrev_b32 v51, 16, v51
  v_fmac_f32 v22, v51, v115
  v_dot2c_f32_bf16 v21, v52, v116
  v_lshlrev_b32 v52, 16, v52
  v_fmac_f32 v20, v52, v116
  v_dot2c_f32_bf16 v23, v53, v117
  v_lshlrev_b32 v53, 16, v53
  v_fmac_f32 v22, v53, v117
  v_dot2c_f32_bf16 v21, v54, v118
  v_lshlrev_b32 v54, 16, v54
  v_fmac_f32 v20, v54, v118
  v_dot2c_f32_bf16 v23, v55, v119
  v_lshlrev_b32 v55, 16, v55
  v_fmac_f32 v22, v55, v119
  v_dot2c_f32_bf16 v21, v56, v120
  v_lshlrev_b32 v56, 16, v56
  v_fmac_f32 v20, v56, v120
  v_dot2c_f32_bf16 v23, v57, v121
  v_lshlrev_b32 v57, 16, v57
  v_fmac_f32 v22, v57, v121
  v_dot2c_f32_bf16 v21, v58, v122
  v_lshlrev_b32 v58, 16, v58
  v_fmac_f32 v20, v58, v122
  v_dot2c_f32_bf16 v23, v59, v123
  v_lshlrev_b32 v59, 16, v59
  v_fmac_f32 v22, v59, v123
  v_add_f32 v20, v20, v22
  v_add_f32 v21, v21, v23
  s_lshl_b32 s47, s24, 9
  v_lshlrev_b32 v18, 8, v6
  v_lshl_add_u32 v18, v13, 3, v18
  v_add_u32 v18, s47, v18
  ds_write_b64 v18, v[20:21] offset:2048
  v_lshlrev_b32 v18, 2, v1
  s_waitcnt lgkmcnt(0)
  s_barrier
  ds_read2st64_b32 v[32:33], v18 offset0:8 offset1:9
  ds_read2st64_b32 v[34:35], v18 offset0:10 offset1:11
  ds_read2st64_b32 v[36:37], v18 offset0:12 offset1:13
  ds_read2st64_b32 v[38:39], v18 offset0:14 offset1:15
  ds_read2st64_b32 v[40:41], v18 offset0:16 offset1:17
  ds_read2st64_b32 v[42:43], v18 offset0:18 offset1:19
  ds_read2st64_b32 v[44:45], v18 offset0:20 offset1:21
  ds_read2st64_b32 v[46:47], v18 offset0:22 offset1:23
  v_mul_u32_u24 v24, 2341, v14
  v_lshrrev_b32 v24, 16, v24
  v_mul_u32_u24 v25, 28, v24
  v_sub_u32 v25, v14, v25
  v_mul_u32_u24 v24, 3, v24
  v_add_u32 v24, s36, v24
  v_mul_u32_u24 v24, 29, v24
  v_lshlrev_b32 v24, 10, v24
  v_lshl_add_u32 v24, v25, 4, v24
  v_add_u32 v24, 0x1c0000, v24
  s_and_b32 s47, s35, 1
  s_lshl_b32 s47, s47, 7
  s_add_u32 s47, s47, s45
  v_lshl_add_u32 v3, v6, 6, s47
  s_waitcnt lgkmcnt(0)
  v_add_f32 v32, v32, v40
  v_add_f32 v33, v33, v41
  v_add_f32 v34, v34, v42
  v_add_f32 v35, v35, v43
  v_add_f32 v36, v36, v44
  v_add_f32 v37, v37, v45
  v_add_f32 v38, v38, v46
  v_add_f32 v39, v39, v47
  v_add_f32 v32, v32, v36
  v_add_f32 v33, v33, v37
  v_add_f32 v34, v34, v38
  v_add_f32 v35, v35, v39
  v_add_f32 v32, v32, v34
  v_add_f32 v33, v33, v35
  v_add_f32 v32, v32, v33
  v_cvt_pk_bf16_f32 v32, v32, v32
  v_and_b32 v32, s34, v32
  v_add_f32 v32, s39, v32
  v_cvt_pk_bf16_f32 v32, v32, v32
  v_and_b32 v32, s34, v32
  v_mul_f32 v32, s40, v32
  s_cmp_lt_u32 s2, 84
  s_cbranch_scc1 P_taskA
  s_cmp_lg_u32 s24, 0
  s_cbranch_scc1 P_end
  s_mul_i32 s35, s35, 1792
  s_lshl_b32 s36, s36, 8
  s_add_u32 s35, s35, s36
  s_add_u32 s35, s35, 3260416
  buffer_store_dword v32, v18, s[20:23], s35 offen
  s_branch P_end
P_taskA:
  s_cmp_eq_u32 s46, 0
  s_cbranch_scc1 P_end
  ds_write_b32 v19, v32 offset:6144
  s_waitcnt lgkmcnt(0)
  ds_read_b128 v[96:99], v3 offset:6144
  ds_read_b128 v[100:103], v3 offset:6160
  ds_read_b128 v[104:107], v3 offset:6176
  ds_read_b128 v[108:111], v3 offset:6192
  s_cmp_ge_u32 s2, 42
  s_cbranch_scc1 P_bias
  s_lshl_b32 s45, s35, 1
  v_add_u32 v26, s45, v6
  v_lshl_add_u32 v26, v26, 10, v24
  s_waitcnt vmcnt(0) lgkmcnt(0)
  v_lshlrev_b32 v32, 16, v64
  v_and_b32 v64, s34, v64
  v_mul_f32 v32, v32, v96
  v_mul_f32 v64, v64, v96
  v_lshlrev_b32 v33, 16, v65
  v_and_b32 v65, s34, v65
  v_mul_f32 v33, v33, v97
  v_mul_f32 v65, v65, v97
  v_lshlrev_b32 v34, 16, v66
  v_and_b32 v66, s34, v66
  v_mul_f32 v34, v34, v98
  v_mul_f32 v66, v66, v98
  v_lshlrev_b32 v35, 16, v67
  v_and_b32 v67, s34, v67
  v_mul_f32 v35, v35, v99
  v_mul_f32 v67, v67, v99
  v_lshlrev_b32 v36, 16, v68
  v_and_b32 v68, s34, v68
  v_mul_f32 v36, v36, v100
  v_mul_f32 v68, v68, v100
  v_lshlrev_b32 v37, 16, v69
  v_and_b32 v69, s34, v69
  v_mul_f32 v37, v37, v101
  v_mul_f32 v69, v69, v101
  v_lshlrev_b32 v38, 16, v70
  v_and_b32 v70, s34, v70
  v_mul_f32 v38, v38, v102
  v_mul_f32 v70, v70, v102
  v_lshlrev_b32 v39, 16, v71
  v_and_b32 v71, s34, v71
  v_mul_f32 v39, v39, v103
  v_mul_f32 v71, v71, v103
  v_lshlrev_b32 v40, 16, v72
  v_and_b32 v72, s34, v72
  v_mul_f32 v40, v40, v104
  v_mul_f32 v72, v72, v104
  v_lshlrev_b32 v41, 16, v73
  v_and_b32 v73, s34, v73
  v_mul_f32 v41, v41, v105
  v_mul_f32 v73, v73, v105
  v_lshlrev_b32 v42, 16, v74
  v_and_b32 v74, s34, v74
  v_mul_f32 v42, v42, v106
  v_mul_f32 v74, v74, v106
  v_lshlrev_b32 v43, 16, v75
  v_and_b32 v75, s34, v75
  v_mul_f32 v43, v43, v107
  v_mul_f32 v75, v75, v107
  v_lshlrev_b32 v44, 16, v76
  v_and_b32 v76, s34, v76
  v_mul_f32 v44, v44, v108
  v_mul_f32 v76, v76, v108
  v_lshlrev_b32 v45, 16, v77
  v_and_b32 v77, s34, v77
  v_mul_f32 v45, v45, v109
  v_mul_f32 v77, v77, v109
  v_lshlrev_b32 v46, 16, v78
  v_and_b32 v78, s34, v78
  v_mul_f32 v46, v46, v110
  v_mul_f32 v78, v78, v110
  v_lshlrev_b32 v47, 16, v79
  v_and_b32 v79, s34, v79
  v_mul_f32 v47, v47, v111
  v_mul_f32 v79, v79, v111
  v_cvt_pk_bf16_f32 v48, v32, v33
  v_cvt_pk_bf16_f32 v49, v34, v35
  v_cvt_pk_bf16_f32 v50, v40, v41
  v_cvt_pk_bf16_f32 v51, v42, v43
  buffer_store_dwordx4 v[48:51], v26, s[20:23], 0 offen offset:0
  v_cvt_pk_bf16_f32 v52, v64, v65
  v_cvt_pk_bf16_f32 v53, v66, v67
  v_cvt_pk_bf16_f32 v54, v72, v73
  v_cvt_pk_bf16_f32 v55, v74, v75
  buffer_store_dwordx4 v[52:55], v26, s[20:23], 0 offen offset:16
  v_cvt_pk_bf16_f32 v56, v36, v37
  v_cvt_pk_bf16_f32 v57, v38, v39
  v_cvt_pk_bf16_f32 v58, v44, v45
  v_cvt_pk_bf16_f32 v59, v46, v47
  buffer_store_dwordx4 v[56:59], v26, s[20:23], 0 offen offset:512
  v_cvt_pk_bf16_f32 v60, v68, v69
  v_cvt_pk_bf16_f32 v61, v70, v71
  v_cvt_pk_bf16_f32 v62, v76, v77
  v_cvt_pk_bf16_f32 v63, v78, v79
  buffer_store_dwordx4 v[60:63], v26, s[20:23], 0 offen offset:528
  s_branch P_end
P_bias:
  s_bfe_u32 s45, s35, 0x10002
  s_lshl_b32 s45, s45, 9
  s_lshr_b32 s47, s35, 3
  s_lshl_b32 s47, s47, 3
  s_and_b32 s48, s35, 3
  s_lshl_b32 s48, s48, 1
  s_add_u32 s45, s45, s47
  s_add_u32 s45, s45, s48
  s_add_u32 s45, s45, 28672
  v_mov_b32 v20, 0
  v_mov_b32 v21, 0
  v_lshl_add_u32 v24, v6, 4, v24
  s_waitcnt vmcnt(0) lgkmcnt(0)
  v_lshlrev_b32 v32, 16, v64
  v_and_b32 v64, s34, v64
  v_fmac_f32 v20, v32, v96
  v_fmac_f32 v21, v64, v96
  v_lshlrev_b32 v33, 16, v65
  v_and_b32 v65, s34, v65
  v_fmac_f32 v20, v33, v97
  v_fmac_f32 v21, v65, v97
  v_lshlrev_b32 v34, 16, v66
  v_and_b32 v66, s34, v66
  v_fmac_f32 v20, v34, v98
  v_fmac_f32 v21, v66, v98
  v_lshlrev_b32 v35, 16, v67
  v_and_b32 v67, s34, v67
  v_fmac_f32 v20, v35, v99
  v_fmac_f32 v21, v67, v99
  v_lshlrev_b32 v36, 16, v68
  v_and_b32 v68, s34, v68
  v_fmac_f32 v20, v36, v100
  v_fmac_f32 v21, v68, v100
  v_lshlrev_b32 v37, 16, v69
  v_and_b32 v69, s34, v69
  v_fmac_f32 v20, v37, v101
  v_fmac_f32 v21, v69, v101
  v_lshlrev_b32 v38, 16, v70
  v_and_b32 v70, s34, v70
  v_fmac_f32 v20, v38, v102
  v_fmac_f32 v21, v70, v102
  v_lshlrev_b32 v39, 16, v71
  v_and_b32 v71, s34, v71
  v_fmac_f32 v20, v39, v103
  v_fmac_f32 v21, v71, v103
  v_lshlrev_b32 v40, 16, v72
  v_and_b32 v72, s34, v72
  v_fmac_f32 v20, v40, v104
  v_fmac_f32 v21, v72, v104
  v_lshlrev_b32 v41, 16, v73
  v_and_b32 v73, s34, v73
  v_fmac_f32 v20, v41, v105
  v_fmac_f32 v21, v73, v105
  v_lshlrev_b32 v42, 16, v74
  v_and_b32 v74, s34, v74
  v_fmac_f32 v20, v42, v106
  v_fmac_f32 v21, v74, v106
  v_lshlrev_b32 v43, 16, v75
  v_and_b32 v75, s34, v75
  v_fmac_f32 v20, v43, v107
  v_fmac_f32 v21, v75, v107
  v_lshlrev_b32 v44, 16, v76
  v_and_b32 v76, s34, v76
  v_fmac_f32 v20, v44, v108
  v_fmac_f32 v21, v76, v108
  v_lshlrev_b32 v45, 16, v77
  v_and_b32 v77, s34, v77
  v_fmac_f32 v20, v45, v109
  v_fmac_f32 v21, v77, v109
  v_lshlrev_b32 v46, 16, v78
  v_and_b32 v78, s34, v78
  v_fmac_f32 v20, v46, v110
  v_fmac_f32 v21, v78, v110
  v_lshlrev_b32 v47, 16, v79
  v_and_b32 v79, s34, v79
  v_fmac_f32 v20, v47, v111
  v_fmac_f32 v21, v79, v111
  s_nop 1
  v_permlane32_swap_b32 v20, v21
  v_add_f32 v20, v20, v21
  v_cvt_pk_bf16_f32 v20, v20, v20
  buffer_store_short v20, v24, s[20:23], s45 offen
  s_cmp_lg_u32 s35, 13
  s_cbranch_scc1 P_end
  v_mov_b32 v21, 0
  s_mov_b32 s45, 29196
  buffer_store_dword v21, v24, s[20:23], s45 offen
  s_branch P_end
P_other:
  s_cmp_ge_u32 s2, 176
  s_cbranch_scc1 P_wo
  s_mov_b32 s16, s4
  s_mov_b32 s17, s5
  s_mov_b32 s18, 0x1c0000
  s_mov_b32 s19, 0x20000
  s_sub_u32 s35, s2, 112
  v_lshrrev_b32 v3, 4, v1
  s_lshl_b32 s36, s24, 2
  v_add_u32 v3, s36, v3
  v_and_b32 v4, 15, v1
  s_lshl_b32 s37, s35, 5
  v_add_u32 v5, s37, v3
  v_mul_u32_u24 v5, 896, v5
  v_lshl_add_u32 v5, v4, 6, v5
  v_cmp_gt_u32 vcc, 14, v4
  s_nop 1
  v_cndmask_b32 v5, -2.0, v5, vcc
  buffer_load_dwordx4 v[16:19], v5, s[16:19], 0 offen
  buffer_load_dwordx4 v[20:23], v5, s[16:19], 0 offen offset:16
  buffer_load_dwordx4 v[24:27], v5, s[16:19], 0 offen offset:32
  buffer_load_dwordx4 v[28:31], v5, s[16:19], 0 offen offset:48
  s_lshl_b32 s40, s35, 3
  s_add_u32 s40, s40, s24
  s_min_u32 s40, s40, 391
  s_cmp_ge_u32 s40, 196
  s_cselect_b32 s60, s62, s60
  s_cselect_b32 s61, s63, s61
  s_cselect_b32 s41, 196, 0
  s_sub_u32 s40, s40, s41
  s_lshl_b32 s40, s40, 13
  v_lshl_add_u32 v9, v1, 7, s40
  v_mov_b32 v101, v9
  s_mul_i32 s38, s35, 28672
  s_add_u32 s38, s38, 0
  v_lshlrev_b32 v7, 11, v4
  v_lshl_add_u32 v7, v3, 4, v7
  v_add_u32 v7, s38, v7
  v_cndmask_b32 v7, -2.0, v7, vcc
  s_mov_b32 s50, 0x3f803f80
  v_mov_b32 v8, 0
  v_mov_b32 v9, 0
  s_waitcnt vmcnt(0)
  global_load_dword v100, v101, s[60:61]
  v_dot2c_f32_bf16 v8, s50, v16
  v_lshlrev_b32 v32, 16, v16
  v_and_b32 v33, s34, v16
  v_dot2c_f32_bf16 v9, s50, v17
  v_lshlrev_b32 v34, 16, v17
  v_and_b32 v35, s34, v17
  v_dot2c_f32_bf16 v8, s50, v18
  v_lshlrev_b32 v36, 16, v18
  v_and_b32 v37, s34, v18
  v_dot2c_f32_bf16 v9, s50, v19
  v_lshlrev_b32 v38, 16, v19
  v_and_b32 v39, s34, v19
  v_dot2c_f32_bf16 v8, s50, v20
  v_lshlrev_b32 v40, 16, v20
  v_and_b32 v41, s34, v20
  v_dot2c_f32_bf16 v9, s50, v21
  v_lshlrev_b32 v42, 16, v21
  v_and_b32 v43, s34, v21
  v_dot2c_f32_bf16 v8, s50, v22
  v_lshlrev_b32 v44, 16, v22
  v_and_b32 v45, s34, v22
  v_dot2c_f32_bf16 v9, s50, v23
  v_lshlrev_b32 v46, 16, v23
  v_and_b32 v47, s34, v23
  v_dot2c_f32_bf16 v8, s50, v24
  v_lshlrev_b32 v48, 16, v24
  v_and_b32 v49, s34, v24
  v_dot2c_f32_bf16 v9, s50, v25
  v_lshlrev_b32 v50, 16, v25
  v_and_b32 v51, s34, v25
  v_dot2c_f32_bf16 v8, s50, v26
  v_lshlrev_b32 v52, 16, v26
  v_and_b32 v53, s34, v26
  v_dot2c_f32_bf16 v9, s50, v27
  v_lshlrev_b32 v54, 16, v27
  v_and_b32 v55, s34, v27
  v_dot2c_f32_bf16 v8, s50, v28
  v_lshlrev_b32 v56, 16, v28
  v_and_b32 v57, s34, v28
  v_dot2c_f32_bf16 v9, s50, v29
  v_lshlrev_b32 v58, 16, v29
  v_and_b32 v59, s34, v29
  v_dot2c_f32_bf16 v8, s50, v30
  v_lshlrev_b32 v60, 16, v30
  v_and_b32 v61, s34, v30
  v_dot2c_f32_bf16 v9, s50, v31
  v_lshlrev_b32 v62, 16, v31
  v_and_b32 v63, s34, v31
  s_nop 0
  v_add_f32 v8, v8, v9
  s_nop 1
  v_add_f32_dpp v8, v8, v8 row_ror:8 row_mask:0xf bank_mask:0xf
  s_nop 1
  v_add_f32_dpp v8, v8, v8 row_ror:4 row_mask:0xf bank_mask:0xf
  s_nop 1
  v_add_f32_dpp v8, v8, v8 row_ror:2 row_mask:0xf bank_mask:0xf
  s_nop 1
  v_add_f32_dpp v8, v8, v8 row_ror:1 row_mask:0xf bank_mask:0xf
  v_mul_f32 v8, 0x3b124925, v8
  v_sub_f32 v32, v32, v8
  v_sub_f32 v33, v33, v8
  v_sub_f32 v34, v34, v8
  v_sub_f32 v35, v35, v8
  v_sub_f32 v36, v36, v8
  v_sub_f32 v37, v37, v8
  v_sub_f32 v38, v38, v8
  v_sub_f32 v39, v39, v8
  v_sub_f32 v40, v40, v8
  v_sub_f32 v41, v41, v8
  v_sub_f32 v42, v42, v8
  v_sub_f32 v43, v43, v8
  v_sub_f32 v44, v44, v8
  v_sub_f32 v45, v45, v8
  v_sub_f32 v46, v46, v8
  v_sub_f32 v47, v47, v8
  v_sub_f32 v48, v48, v8
  v_sub_f32 v49, v49, v8
  v_sub_f32 v50, v50, v8
  v_sub_f32 v51, v51, v8
  v_sub_f32 v52, v52, v8
  v_sub_f32 v53, v53, v8
  v_sub_f32 v54, v54, v8
  v_sub_f32 v55, v55, v8
  v_sub_f32 v56, v56, v8
  v_sub_f32 v57, v57, v8
  v_sub_f32 v58, v58, v8
  v_sub_f32 v59, v59, v8
  v_sub_f32 v60, v60, v8
  v_sub_f32 v61, v61, v8
  v_sub_f32 v62, v62, v8
  v_sub_f32 v63, v63, v8
  v_mul_f32 v9, v32, v32
  v_mul_f32 v10, v33, v33
  v_fmac_f32 v9, v34, v34
  v_fmac_f32 v10, v35, v35
  v_fmac_f32 v9, v36, v36
  v_fmac_f32 v10, v37, v37
  v_fmac_f32 v9, v38, v38
  v_fmac_f32 v10, v39, v39
  v_fmac_f32 v9, v40, v40
  v_fmac_f32 v10, v41, v41
  v_fmac_f32 v9, v42, v42
  v_fmac_f32 v10, v43, v43
  v_fmac_f32 v9, v44, v44
  v_fmac_f32 v10, v45, v45
  v_fmac_f32 v9, v46, v46
  v_fmac_f32 v10, v47, v47
  v_fmac_f32 v9, v48, v48
  v_fmac_f32 v10, v49, v49
  v_fmac_f32 v9, v50, v50
  v_fmac_f32 v10, v51, v51
  v_fmac_f32 v9, v52, v52
  v_fmac_f32 v10, v53, v53
  v_fmac_f32 v9, v54, v54
  v_fmac_f32 v10, v55, v55
  v_fmac_f32 v9, v56, v56
  v_fmac_f32 v10, v57, v57
  v_fmac_f32 v9, v58, v58
  v_fmac_f32 v10, v59, v59
  v_fmac_f32 v9, v60, v60
  v_fmac_f32 v10, v61, v61
  v_fmac_f32 v9, v62, v62
  v_fmac_f32 v10, v63, v63
  v_add_f32 v9, v9, v10
  v_cndmask_b32 v9, 0, v9, vcc
  s_nop 1
  v_add_f32_dpp v9, v9, v9 row_ror:8 row_mask:0xf bank_mask:0xf
  s_nop 1
  v_add_f32_dpp v9, v9, v9 row_ror:4 row_mask:0xf bank_mask:0xf
  s_nop 1
  v_add_f32_dpp v9, v9, v9 row_ror:2 row_mask:0xf bank_mask:0xf
  s_nop 1
  v_add_f32_dpp v9, v9, v9 row_ror:1 row_mask:0xf bank_mask:0xf
  v_mov_b32 v10, 0x3727c5ac
  v_fmac_f32 v10, 0x3b124925, v9
  v_rsq_f32 v10, v10
  s_nop 0
  v_mul_f32 v32, v32, v10
  v_mul_f32 v33, v33, v10
  v_mul_f32 v34, v34, v10
  v_mul_f32 v35, v35, v10
  v_mul_f32 v36, v36, v10
  v_mul_f32 v37, v37, v10
  v_mul_f32 v38, v38, v10
  v_mul_f32 v39, v39, v10
  v_mul_f32 v40, v40, v10
  v_mul_f32 v41, v41, v10
  v_mul_f32 v42, v42, v10
  v_mul_f32 v43, v43, v10
  v_mul_f32 v44, v44, v10
  v_mul_f32 v45, v45, v10
  v_mul_f32 v46, v46, v10
  v_mul_f32 v47, v47, v10
  v_mul_f32 v48, v48, v10
  v_mul_f32 v49, v49, v10
  v_mul_f32 v50, v50, v10
  v_mul_f32 v51, v51, v10
  v_mul_f32 v52, v52, v10
  v_mul_f32 v53, v53, v10
  v_mul_f32 v54, v54, v10
  v_mul_f32 v55, v55, v10
  v_mul_f32 v56, v56, v10
  v_mul_f32 v57, v57, v10
  v_mul_f32 v58, v58, v10
  v_mul_f32 v59, v59, v10
  v_mul_f32 v60, v60, v10
  v_mul_f32 v61, v61, v10
  v_mul_f32 v62, v62, v10
  v_mul_f32 v63, v63, v10
  v_cvt_pk_bf16_f32 v16, v32, v33
  v_cvt_pk_bf16_f32 v17, v34, v35
  v_cvt_pk_bf16_f32 v18, v40, v41
  v_cvt_pk_bf16_f32 v19, v42, v43
  buffer_store_dwordx4 v[16:19], v7, s[20:23], 0 offen offset:0
  v_cvt_pk_bf16_f32 v20, v36, v37
  v_cvt_pk_bf16_f32 v21, v38, v39
  v_cvt_pk_bf16_f32 v22, v44, v45
  v_cvt_pk_bf16_f32 v23, v46, v47
  buffer_store_dwordx4 v[20:23], v7, s[20:23], 0 offen offset:512
  v_cvt_pk_bf16_f32 v24, v48, v49
  v_cvt_pk_bf16_f32 v25, v50, v51
  v_cvt_pk_bf16_f32 v26, v56, v57
  v_cvt_pk_bf16_f32 v27, v58, v59
  buffer_store_dwordx4 v[24:27], v7, s[20:23], 0 offen offset:1024
  v_cvt_pk_bf16_f32 v28, v52, v53
  v_cvt_pk_bf16_f32 v29, v54, v55
  v_cvt_pk_bf16_f32 v30, v60, v61
  v_cvt_pk_bf16_f32 v31, v62, v63
  buffer_store_dwordx4 v[28:31], v7, s[20:23], 0 offen offset:1536
  s_branch P_end
P_wo:
  s_cmp_ge_u32 s2, 198
  s_cbranch_scc1 P_wd
  s_cmp_ge_u32 s2, 190
  s_cbranch_scc1 P_warm
  s_mov_b32 s16, s36
  s_mov_b32 s17, s37
  s_mov_b32 s18, 0x62000
  s_mov_b32 s19, 0x20000
  s_sub_u32 s25, s2, 176
  s_mov_b32 s40, 28
  s_mov_b32 s41, 32
  s_mov_b32 s43, 11657216
  s_mov_b32 s44, 0
  s_branch P_wx
P_wd:
  s_mov_b32 s16, s56
  s_mov_b32 s17, s57
  s_mov_b32 s18, 0x188000
  s_mov_b32 s19, 0x20000
  s_sub_u32 s25, s2, 198
  s_mov_b32 s40, 32
  s_movk_i32 s41, 112
  s_mov_b32 s43, 25255936
  s_mov_b32 s44, -1
P_wx:
  s_lshl_b32 s25, s25, 3
  s_add_u32 s25, s25, s24
  s_mul_i32 s35, s25, 9363
  s_lshr_b32 s35, s35, 16
  s_mul_i32 s36, s35, 7
  s_sub_u32 s36, s25, s36
  s_mul_i32 s42, s35, s40
  v_lshl_add_u32 v15, v6, 4, s42
  s_lshl_b32 s47, s36, 6
  v_lshl_add_u32 v14, v13, 1, s47
  v_mul_u32_u24 v16, 896, v15
  v_lshl_add_u32 v16, v14, 1, v16
  buffer_load_dword v64, v16, s[16:19], 0 offen offset:0
  s_waitcnt vmcnt(0)
  buffer_load_dword v65, v16, s[16:19], 0 offen offset:896
  buffer_load_dword v66, v16, s[16:19], 0 offen offset:1792
  buffer_load_dword v67, v16, s[16:19], 0 offen offset:2688
  s_movk_i32 s45, 3584
  buffer_load_dword v68, v16, s[16:19], s45 offen offset:0
  buffer_load_dword v69, v16, s[16:19], s45 offen offset:896
  buffer_load_dword v70, v16, s[16:19], s45 offen offset:1792
  buffer_load_dword v71, v16, s[16:19], s45 offen offset:2688
  s_movk_i32 s45, 7168
  buffer_load_dword v72, v16, s[16:19], s45 offen offset:0
  buffer_load_dword v73, v16, s[16:19], s45 offen offset:896
  buffer_load_dword v74, v16, s[16:19], s45 offen offset:1792
  buffer_load_dword v75, v16, s[16:19], s45 offen offset:2688
  s_movk_i32 s45, 10752
  buffer_load_dword v76, v16, s[16:19], s45 offen offset:0
  buffer_load_dword v77, v16, s[16:19], s45 offen offset:896
  buffer_load_dword v78, v16, s[16:19], s45 offen offset:1792
  buffer_load_dword v79, v16, s[16:19], s45 offen offset:2688
  v_lshrrev_b32 v24, 5, v14
  v_and_b32 v25, 16, v14
  v_and_b32 v27, 3, v1
  v_lshl_add_u32 v25, v27, 1, v25
  v_bfe_u32 v27, v1, 2, 1
  v_add_u32 v25, v25, v27
  v_mul_u32_u24 v24, s41, v24
  s_lshl_b32 s45, s35, 1
  v_add_u32 v24, s45, v24
  v_add_u32 v24, v24, v6
  v_lshlrev_b32 v24, 10, v24
  v_lshl_add_u32 v24, v25, 4, v24
  v_add_u32 v26, s43, v24
  s_mov_b32 s46, 0x05040100
  s_mov_b32 s47, 0x07060302
  s_waitcnt vmcnt(0)
  s_mov_b32 exec_lo, 0
  v_and_b32 v76, s44, v76
  v_and_b32 v77, s44, v77
  v_and_b32 v78, s44, v78
  v_and_b32 v79, s44, v79
  s_mov_b64 exec, -1
  v_perm_b32 v48, v65, v64, s46
  v_perm_b32 v52, v65, v64, s47
  v_mov_b32 v80, v52
  v_perm_b32 v49, v67, v66, s46
  v_perm_b32 v53, v67, v66, s47
  v_mov_b32 v81, v53
  v_perm_b32 v50, v73, v72, s46
  v_perm_b32 v54, v73, v72, s47
  v_mov_b32 v82, v54
  v_perm_b32 v51, v75, v74, s46
  v_perm_b32 v55, v75, v74, s47
  v_mov_b32 v83, v55
  v_mov_b32_dpp v52, v48 row_shl:4 row_mask:0xf bank_mask:0x5
  v_mov_b32_dpp v53, v49 row_shl:4 row_mask:0xf bank_mask:0x5
  v_mov_b32_dpp v54, v50 row_shl:4 row_mask:0xf bank_mask:0x5
  v_mov_b32_dpp v55, v51 row_shl:4 row_mask:0xf bank_mask:0x5
  v_mov_b32_dpp v48, v80 row_shr:4 row_mask:0xf bank_mask:0xa
  v_mov_b32_dpp v49, v81 row_shr:4 row_mask:0xf bank_mask:0xa
  v_mov_b32_dpp v50, v82 row_shr:4 row_mask:0xf bank_mask:0xa
  v_mov_b32_dpp v51, v83 row_shr:4 row_mask:0xf bank_mask:0xa
  buffer_store_dwordx4 v[48:51], v26, s[20:23], 0 offen offset:0
  buffer_store_dwordx4 v[52:55], v26, s[20:23], 0 offen offset:128
  v_perm_b32 v56, v69, v68, s46
  v_perm_b32 v60, v69, v68, s47
  v_mov_b32 v80, v60
  v_perm_b32 v57, v71, v70, s46
  v_perm_b32 v61, v71, v70, s47
  v_mov_b32 v81, v61
  v_perm_b32 v58, v77, v76, s46
  v_perm_b32 v62, v77, v76, s47
  v_mov_b32 v82, v62
  v_perm_b32 v59, v79, v78, s46
  v_perm_b32 v63, v79, v78, s47
  v_mov_b32 v83, v63
  v_mov_b32_dpp v60, v56 row_shl:4 row_mask:0xf bank_mask:0x5
  v_mov_b32_dpp v61, v57 row_shl:4 row_mask:0xf bank_mask:0x5
  v_mov_b32_dpp v62, v58 row_shl:4 row_mask:0xf bank_mask:0x5
  v_mov_b32_dpp v63, v59 row_shl:4 row_mask:0xf bank_mask:0x5
  v_mov_b32_dpp v56, v80 row_shr:4 row_mask:0xf bank_mask:0xa
  v_mov_b32_dpp v57, v81 row_shr:4 row_mask:0xf bank_mask:0xa
  v_mov_b32_dpp v58, v82 row_shr:4 row_mask:0xf bank_mask:0xa
  v_mov_b32_dpp v59, v83 row_shr:4 row_mask:0xf bank_mask:0xa
  buffer_store_dwordx4 v[56:59], v26, s[20:23], 0 offen offset:512
  buffer_store_dwordx4 v[60:63], v26, s[20:23], 0 offen offset:640
  s_branch P_end
P_warm:
  s_getpc_b64 s[52:53]
P_warm_pc:
  s_add_u32 s52, s52, mega_kernel-P_warm_pc
  s_addc_u32 s53, s53, 0
  v_lshlrev_b32 v9, 7, v0
  s_mov_b32 s35, mega_end-mega_kernel
  v_cmp_gt_u32 vcc, s35, v9
  s_nop 0
  s_and_saveexec_b64 s[54:55], vcc
  s_cbranch_execz P_warm2
  global_load_dword v101, v9, s[52:53]
P_warm2:
  s_mov_b64 exec, s[54:55]
  s_sub_u32 s35, s2, 190
  s_lshl_b32 s35, s35, 9
  v_add_u32 v9, s35, v0
  v_lshlrev_b32 v10, 4, v9
  v_lshlrev_b32 v9, 8, v9
  v_mov_b32 v12, 0
  v_mov_b32 v13, 0
  v_mov_b32 v14, 0
  v_mov_b32 v15, 0
  s_mov_b32 s36, 26861568
  buffer_store_dwordx4 v[12:15], v10, s[20:23], s36 offen sc1
  v_and_b32 v10, 0x3fff, v10
  s_mov_b32 s36, 26927104
  buffer_store_dwordx4 v[12:15], v10, s[20:23], s36 offen sc1
  v_lshrrev_b32 v9, 6, v9
  v_and_b32 v10, 56, v9
  v_cmp_eq_u32 vcc, 56, v10
  v_mov_b32 v12, 0x5a17c0de
  s_nop 0
  v_cndmask_b32 v11, 0, v12, vcc
  s_mov_b32 s36, 26959872
  v_cmp_gt_u32 vcc, 3584, v9
  s_nop 0
  s_and_saveexec_b64 s[54:55], vcc
  s_cbranch_execz P_end
  buffer_store_dword v11, v9, s[20:23], s36 offen sc1
P_end:
P_exit:
  s_endpgm
.section .rodata,"a"
.p2align 6
.amdhsa_kernel prep_kernel
  .amdhsa_next_free_vgpr 128
  .amdhsa_next_free_sgpr 96
  .amdhsa_accum_offset 128
  .amdhsa_group_segment_fixed_size 0
  .amdhsa_kernarg_size 96
  .amdhsa_user_sgpr_count 2
  .amdhsa_user_sgpr_kernarg_segment_ptr 1
  .amdhsa_system_sgpr_workgroup_id_x 1
.end_amdhsa_kernel
.text
.globl mega_kernel
.p2align 8
.type mega_kernel,@function
mega_kernel:
  s_cmp_ge_u32 s2, 256
  s_cbranch_scc1 M_exit
  s_load_dwordx2 s[32:33], s[0:1], 88
  s_load_dwordx2 s[4:5], s[0:1], 0
  s_load_dwordx2 s[6:7], s[0:1], 72
  s_load_dwordx4 s[72:75], s[0:1], 32
  v_and_b32 v1, 63, v0
  v_lshrrev_b32 v2, 6, v0
  v_lshlrev_b32 v3, 4, v1
  v_readfirstlane_b32 s24, v2
  s_and_b32 s60, s2, 7
  s_lshr_b32 s61, s2, 3
  s_and_b32 s63, s61, 3
  s_lshl_b32 s63, s63, 8
  s_mov_b32 s34, 0xffff0000
  s_mov_b32 s50, 0x3f803f80
  s_and_b32 s25, s60, 1
  s_lshl_b32 s25, s25, 3
  s_and_b32 s26, s61, 7
  s_add_u32 s25, s25, s26
  s_lshr_b32 s26, s60, 1
  s_lshl_b32 s26, s26, 2
  s_lshr_b32 s27, s61, 3
  s_add_u32 s26, s26, s27
  s_lshl_b32 s26, s26, 2
  s_add_u32 s26, s26, s24
  s_mul_i32 s27, s26, 28672
  s_add_u32 s27, s27, 0
  s_mul_i32 s28, s25, 89088
  s_add_u32 s28, s28, 1835008
  s_lshl_b32 s29, s24, 10
  s_min_u32 s35, s24, 2
  s_mul_i32 s35, s35, 29696
  s_add_u32 s35, s35, 28672
  s_waitcnt lgkmcnt(0)
  s_mov_b32 s20, s32
  s_mov_b32 s21, s33
  s_mov_b32 s22, 0x10000000
  s_mov_b32 s23, 0x20000
  s_add_u32 s30, s29, 0
  s_mov_b32 m0, s30
  s_add_u32 s31, s28, s30
  buffer_load_dwordx4 v3, s[20:23], s31 offen lds
  s_add_u32 s30, s29, 29696
  s_mov_b32 m0, s30
  s_add_u32 s31, s28, s30
  buffer_load_dwordx4 v3, s[20:23], s31 offen lds
  s_add_u32 s30, s29, 59392
  s_mov_b32 m0, s30
  s_add_u32 s31, s28, s30
  buffer_load_dwordx4 v3, s[20:23], s31 offen lds
  s_add_u32 s36, s27, 0
  buffer_load_dwordx4 v[64:67], v3, s[20:23], s36 offen offset:0
  buffer_load_dwordx4 v[68:71], v3, s[20:23], s36 offen offset:1024
  buffer_load_dwordx4 v[72:75], v3, s[20:23], s36 offen offset:2048
  buffer_load_dwordx4 v[76:79], v3, s[20:23], s36 offen offset:3072
  s_add_u32 s30, s29, 4096
  s_mov_b32 m0, s30
  s_add_u32 s31, s28, s30
  buffer_load_dwordx4 v3, s[20:23], s31 offen lds
  s_add_u32 s30, s29, 33792
  s_mov_b32 m0, s30
  s_add_u32 s31, s28, s30
  buffer_load_dwordx4 v3, s[20:23], s31 offen lds
  s_add_u32 s30, s29, 63488
  s_mov_b32 m0, s30
  s_add_u32 s31, s28, s30
  buffer_load_dwordx4 v3, s[20:23], s31 offen lds
  s_add_u32 s36, s27, 4096
  buffer_load_dwordx4 v[80:83], v3, s[20:23], s36 offen offset:0
  buffer_load_dwordx4 v[84:87], v3, s[20:23], s36 offen offset:1024
  buffer_load_dwordx4 v[88:91], v3, s[20:23], s36 offen offset:2048
  buffer_load_dwordx4 v[92:95], v3, s[20:23], s36 offen offset:3072
  s_add_u32 s30, s29, 8192
  s_mov_b32 m0, s30
  s_add_u32 s31, s28, s30
  buffer_load_dwordx4 v3, s[20:23], s31 offen lds
  s_add_u32 s30, s29, 37888
  s_mov_b32 m0, s30
  s_add_u32 s31, s28, s30
  buffer_load_dwordx4 v3, s[20:23], s31 offen lds
  s_add_u32 s30, s29, 67584
  s_mov_b32 m0, s30
  s_add_u32 s31, s28, s30
  buffer_load_dwordx4 v3, s[20:23], s31 offen lds
  s_add_u32 s36, s27, 8192
  buffer_load_dwordx4 v[96:99], v3, s[20:23], s36 offen offset:0
  buffer_load_dwordx4 v[100:103], v3, s[20:23], s36 offen offset:1024
  buffer_load_dwordx4 v[104:107], v3, s[20:23], s36 offen offset:2048
  buffer_load_dwordx4 v[108:111], v3, s[20:23], s36 offen offset:3072
  s_mov_b32 s16, s4
  s_mov_b32 s17, s5
  s_mov_b32 s18, 0x1c0000
  s_mov_b32 s19, 0x20000
  s_mov_b32 s12, s6
  s_mov_b32 s13, s7
  s_mov_b32 s14, 0x1c0000
  s_mov_b32 s15, 0x20000
  v_mov_b32 v200, s50
  v_mov_b32 v201, s50
  v_mov_b32 v202, s50
  v_mov_b32 v203, s50
  v_add_u32 v6, 59392, v3
  s_mul_i32 s78, s2, 3
  s_add_u32 s78, s78, s24
  s_add_u32 s79, s2, 768
  s_cmp_eq_u32 s24, 3
  s_cselect_b32 s78, s79, s78
  s_mul_i32 s79, s78, 1171
  s_lshr_b32 s79, s79, 16
  s_mul_i32 s80, s79, 56
  s_sub_u32 s80, s78, s80
  s_cmp_ge_u32 s80, 28
  s_cselect_b32 s8, s74, s72
  s_cselect_b32 s9, s75, s73
  s_cselect_b32 s81, 1, 0
  s_cmp_lt_u32 s78, 784
  s_cselect_b32 s10, 1605632, 0
  s_mov_b32 s11, 0x20000
  s_mul_i32 s82, s81, 28
  s_sub_u32 s80, s80, s82
  s_lshl_b32 s83, s80, 6
  v_lshrrev_b32 v7, 5, v1
  v_and_b32 v10, 31, v1
  v_lshl_add_u32 v14, v10, 1, s83
  v_mul_u32_u24 v11, 57344, v7
  v_lshl_add_u32 v11, v14, 1, v11
  s_mul_i32 s85, s79, 114688
  v_lshrrev_b32 v13, 4, v14
  s_lshl_b32 s82, s81, 4
  v_and_b32 v12, 15, v14
  v_add3_u32 v12, v12, v7, s82
  v_lshl_add_u32 v12, v13, 5, v12
  v_and_b32 v14, 3, v1
  v_lshlrev_b32 v14, 1, v14
  v_bfe_u32 v10, v1, 2, 1
  v_add3_u32 v14, v14, v10, s82
  v_mul_u32_u24 v13, 28, v13
  v_add_u32 v13, v13, v7
  v_lshlrev_b32 v13, 10, v13
  v_lshl_add_u32 v13, v14, 4, v13
  v_lshlrev_b32 v9, 6, v7
  s_lshl_b32 s82, s79, 11
  s_add_u32 s82, s82, 13950976
  v_lshlrev_b32 v12, 3, v12
  s_mul_i32 s83, s79, 28672
  s_add_u32 s83, s83, 17162240
  s_lshl_b32 s84, s79, 7
  s_add_u32 s84, s84, 3260416
  s_mul_i32 s86, s81, 28
  s_add_u32 s86, s86, s80
  s_lshl_b32 s86, s86, 6
  s_lshl_b32 s87, s79, 2
  s_add_u32 s86, s86, s87
  s_add_u32 s86, s86, 26959872
  s_cmp_ge_u32 s78, 784
  s_cmov_b32 s86, 1073741824
  s_cmov_b32 s82, 1073741824
  s_cmov_b32 s83, 1073741824
  s_waitcnt vmcnt(14)
  s_barrier
  ds_read_b128 v[176:179], v3 offset:0
  ds_read_b128 v[180:183], v3 offset:29696
  ds_read_b128 v[184:187], v6 offset:0
  ds_read_b128 v[188:191], v3 offset:1024
  ds_read_b128 v[192:195], v3 offset:30720
  ds_read_b128 v[196:199], v6 offset:1024
  s_waitcnt lgkmcnt(3)
  v_mfma_f32_32x32x16_bf16 v[16:31], v[176:179], v[64:67], 0
  s_add_u32 s30, s29, 12288
  s_mov_b32 m0, s30
  s_add_u32 s31, s28, s30
  buffer_load_dwordx4 v3, s[20:23], s31 offen lds
  v_mfma_f32_32x32x16_bf16 v[32:47], v[180:183], v[64:67], 0
  s_add_u32 s30, s29, 41984
  s_mov_b32 m0, s30
  s_add_u32 s31, s28, s30
  buffer_load_dwordx4 v3, s[20:23], s31 offen lds
  v_mfma_f32_32x32x16_bf16 v[48:63], v[64:67], v[184:187], 0
  ds_read_b128 v[176:179], v3 offset:2048
  ds_read_b128 v[180:183], v3 offset:31744
  ds_read_b128 v[184:187], v6 offset:2048
  s_waitcnt lgkmcnt(3)
  v_mfma_f32_32x32x16_bf16 v[16:31], v[188:191], v[68:71], v[16:31]
  s_add_u32 s30, s29, 71680
  s_mov_b32 m0, s30
  s_add_u32 s31, s28, s30
  buffer_load_dwordx4 v3, s[20:23], s31 offen lds
  v_mfma_f32_32x32x16_bf16 v[32:47], v[192:195], v[68:71], v[32:47]
  s_add_u32 s36, s27, 12288
  buffer_load_dwordx4 v[112:115], v3, s[20:23], s36 offen offset:0
  v_mfma_f32_32x32x16_bf16 v[48:63], v[68:71], v[196:199], v[48:63]
  ds_read_b128 v[188:191], v3 offset:3072
  ds_read_b128 v[192:195], v3 offset:32768
  ds_read_b128 v[196:199], v6 offset:3072
  s_waitcnt lgkmcnt(3)
  v_mfma_f32_32x32x16_bf16 v[16:31], v[176:179], v[72:75], v[16:31]
  buffer_load_dwordx4 v[116:119], v3, s[20:23], s36 offen offset:1024
  v_mfma_f32_32x32x16_bf16 v[32:47], v[180:183], v[72:75], v[32:47]
  buffer_load_dwordx4 v[120:123], v3, s[20:23], s36 offen offset:2048
  v_mfma_f32_32x32x16_bf16 v[48:63], v[72:75], v[184:187], v[48:63]
  s_waitcnt lgkmcnt(0)
  v_mfma_f32_32x32x16_bf16 v[16:31], v[188:191], v[76:79], v[16:31]
  buffer_load_dwordx4 v[124:127], v3, s[20:23], s36 offen offset:3072
  v_mfma_f32_32x32x16_bf16 v[32:47], v[192:195], v[76:79], v[32:47]
  v_mfma_f32_32x32x16_bf16 v[48:63], v[76:79], v[196:199], v[48:63]
  s_waitcnt vmcnt(14)
  s_barrier
  ds_read_b128 v[176:179], v3 offset:4096
  ds_read_b128 v[180:183], v3 offset:33792
  ds_read_b128 v[184:187], v6 offset:4096
  ds_read_b128 v[188:191], v3 offset:5120
  ds_read_b128 v[192:195], v3 offset:34816
  ds_read_b128 v[196:199], v6 offset:5120
  s_waitcnt lgkmcnt(3)
  v_mfma_f32_32x32x16_bf16 v[16:31], v[176:179], v[80:83], v[16:31]
  s_add_u32 s30, s29, 16384
  s_mov_b32 m0, s30
  s_add_u32 s31, s28, s30
  buffer_load_dwordx4 v3, s[20:23], s31 offen lds
  v_mfma_f32_32x32x16_bf16 v[32:47], v[180:183], v[80:83], v[32:47]
  s_add_u32 s30, s29, 46080
  s_mov_b32 m0, s30
  s_add_u32 s31, s28, s30
  buffer_load_dwordx4 v3, s[20:23], s31 offen lds
  v_mfma_f32_32x32x16_bf16 v[48:63], v[80:83], v[184:187], v[48:63]
  ds_read_b128 v[176:179], v3 offset:6144
  ds_read_b128 v[180:183], v3 offset:35840
  ds_read_b128 v[184:187], v6 offset:6144
  s_waitcnt lgkmcnt(3)
  v_mfma_f32_32x32x16_bf16 v[16:31], v[188:191], v[84:87], v[16:31]
  s_add_u32 s30, s29, 75776
  s_mov_b32 m0, s30
  s_add_u32 s31, s28, s30
  buffer_load_dwordx4 v3, s[20:23], s31 offen lds
  v_mfma_f32_32x32x16_bf16 v[32:47], v[192:195], v[84:87], v[32:47]
  s_add_u32 s36, s27, 16384
  buffer_load_dwordx4 v[128:131], v3, s[20:23], s36 offen offset:0
  v_mfma_f32_32x32x16_bf16 v[48:63], v[84:87], v[196:199], v[48:63]
  ds_read_b128 v[188:191], v3 offset:7168
  ds_read_b128 v[192:195], v3 offset:36864
  ds_read_b128 v[196:199], v6 offset:7168
  s_waitcnt lgkmcnt(3)
  v_mfma_f32_32x32x16_bf16 v[16:31], v[176:179], v[88:91], v[16:31]
  buffer_load_dwordx4 v[132:135], v3, s[20:23], s36 offen offset:1024
  v_mfma_f32_32x32x16_bf16 v[32:47], v[180:183], v[88:91], v[32:47]
  buffer_load_dwordx4 v[136:139], v3, s[20:23], s36 offen offset:2048
  v_mfma_f32_32x32x16_bf16 v[48:63], v[88:91], v[184:187], v[48:63]
  s_waitcnt lgkmcnt(0)
  v_mfma_f32_32x32x16_bf16 v[16:31], v[188:191], v[92:95], v[16:31]
  buffer_load_dwordx4 v[140:143], v3, s[20:23], s36 offen offset:3072
  v_mfma_f32_32x32x16_bf16 v[32:47], v[192:195], v[92:95], v[32:47]
  v_mfma_f32_32x32x16_bf16 v[48:63], v[92:95], v[196:199], v[48:63]
  s_waitcnt vmcnt(14)
  s_barrier
  ds_read_b128 v[176:179], v3 offset:8192
  ds_read_b128 v[180:183], v3 offset:37888
  ds_read_b128 v[184:187], v6 offset:8192
  ds_read_b128 v[188:191], v3 offset:9216
  ds_read_b128 v[192:195], v3 offset:38912
  ds_read_b128 v[196:199], v6 offset:9216
  s_waitcnt lgkmcnt(3)
  v_mfma_f32_32x32x16_bf16 v[16:31], v[176:179], v[96:99], v[16:31]
  s_add_u32 s30, s29, 20480
  s_mov_b32 m0, s30
  s_add_u32 s31, s28, s30
  buffer_load_dwordx4 v3, s[20:23], s31 offen lds
  v_mfma_f32_32x32x16_bf16 v[32:47], v[180:183], v[96:99], v[32:47]
  s_add_u32 s30, s29, 50176
  s_mov_b32 m0, s30
  s_add_u32 s31, s28, s30
  buffer_load_dwordx4 v3, s[20:23], s31 offen lds
  v_mfma_f32_32x32x16_bf16 v[48:63], v[96:99], v[184:187], v[48:63]
  ds_read_b128 v[176:179], v3 offset:10240
  ds_read_b128 v[180:183], v3 offset:39936
  ds_read_b128 v[184:187], v6 offset:10240
  s_waitcnt lgkmcnt(3)
  v_mfma_f32_32x32x16_bf16 v[16:31], v[188:191], v[100:103], v[16:31]
  s_add_u32 s30, s29, 79872
  s_mov_b32 m0, s30
  s_add_u32 s31, s28, s30
  buffer_load_dwordx4 v3, s[20:23], s31 offen lds
  v_mfma_f32_32x32x16_bf16 v[32:47], v[192:195], v[100:103], v[32:47]
  s_add_u32 s36, s27, 20480
  buffer_load_dwordx4 v[144:147], v3, s[20:23], s36 offen offset:0
  v_mfma_f32_32x32x16_bf16 v[48:63], v[100:103], v[196:199], v[48:63]
  ds_read_b128 v[188:191], v3 offset:11264
  ds_read_b128 v[192:195], v3 offset:40960
  ds_read_b128 v[196:199], v6 offset:11264
  s_waitcnt lgkmcnt(3)
  v_mfma_f32_32x32x16_bf16 v[16:31], v[176:179], v[104:107], v[16:31]
  buffer_load_dwordx4 v[148:151], v3, s[20:23], s36 offen offset:1024
  v_mfma_f32_32x32x16_bf16 v[32:47], v[180:183], v[104:107], v[32:47]
  buffer_load_dwordx4 v[152:155], v3, s[20:23], s36 offen offset:2048
  v_mfma_f32_32x32x16_bf16 v[48:63], v[104:107], v[184:187], v[48:63]
  s_waitcnt lgkmcnt(0)
  v_mfma_f32_32x32x16_bf16 v[16:31], v[188:191], v[108:111], v[16:31]
  buffer_load_dwordx4 v[156:159], v3, s[20:23], s36 offen offset:3072
  v_mfma_f32_32x32x16_bf16 v[32:47], v[192:195], v[108:111], v[32:47]
  v_mfma_f32_32x32x16_bf16 v[48:63], v[108:111], v[196:199], v[48:63]
  s_waitcnt vmcnt(14)
  s_barrier
  ds_read_b128 v[176:179], v3 offset:12288
  ds_read_b128 v[180:183], v3 offset:41984
  ds_read_b128 v[184:187], v6 offset:12288
  ds_read_b128 v[188:191], v3 offset:13312
  ds_read_b128 v[192:195], v3 offset:43008
  ds_read_b128 v[196:199], v6 offset:13312
  s_waitcnt lgkmcnt(3)
  v_mfma_f32_32x32x16_bf16 v[16:31], v[176:179], v[112:115], v[16:31]
  s_add_u32 s30, s29, 24576
  s_mov_b32 m0, s30
  s_add_u32 s31, s28, s30
  buffer_load_dwordx4 v3, s[20:23], s31 offen lds
  v_mfma_f32_32x32x16_bf16 v[32:47], v[180:183], v[112:115], v[32:47]
  s_add_u32 s30, s29, 54272
  s_mov_b32 m0, s30
  s_add_u32 s31, s28, s30
  buffer_load_dwordx4 v3, s[20:23], s31 offen lds
  v_mfma_f32_32x32x16_bf16 v[48:63], v[112:115], v[184:187], v[48:63]
  ds_read_b128 v[176:179], v3 offset:14336
  ds_read_b128 v[180:183], v3 offset:44032
  ds_read_b128 v[184:187], v6 offset:14336
  s_waitcnt lgkmcnt(3)
  v_mfma_f32_32x32x16_bf16 v[16:31], v[188:191], v[116:119], v[16:31]
  s_add_u32 s30, s29, 83968
  s_mov_b32 m0, s30
  s_add_u32 s31, s28, s30
  buffer_load_dwordx4 v3, s[20:23], s31 offen lds
  v_mfma_f32_32x32x16_bf16 v[32:47], v[192:195], v[116:119], v[32:47]
  s_mov_b32 m0, s35
  s_add_u32 s31, s28, s35
  buffer_load_dwordx4 v3, s[20:23], s31 offen lds
  v_mfma_f32_32x32x16_bf16 v[48:63], v[116:119], v[196:199], v[48:63]
  ds_read_b128 v[188:191], v3 offset:15360
  ds_read_b128 v[192:195], v3 offset:45056
  ds_read_b128 v[196:199], v6 offset:15360
  s_waitcnt lgkmcnt(3)
  v_mfma_f32_32x32x16_bf16 v[16:31], v[176:179], v[120:123], v[16:31]
  s_add_u32 s36, s27, 24576
  buffer_load_dwordx4 v[160:163], v3, s[20:23], s36 offen offset:0
  v_mfma_f32_32x32x16_bf16 v[32:47], v[180:183], v[120:123], v[32:47]
  buffer_load_dwordx4 v[164:167], v3, s[20:23], s36 offen offset:1024
  v_mfma_f32_32x32x16_bf16 v[48:63], v[120:123], v[184:187], v[48:63]
  s_waitcnt lgkmcnt(0)
  v_mfma_f32_32x32x16_bf16 v[16:31], v[188:191], v[124:127], v[16:31]
  buffer_load_dwordx4 v[168:171], v3, s[20:23], s36 offen offset:2048
  v_mfma_f32_32x32x16_bf16 v[32:47], v[192:195], v[124:127], v[32:47]
  buffer_load_dwordx4 v[172:175], v3, s[20:23], s36 offen offset:3072
  v_mfma_f32_32x32x16_bf16 v[48:63], v[124:127], v[196:199], v[48:63]
  s_waitcnt vmcnt(15)
  s_barrier
  ds_read_b128 v[176:179], v3 offset:16384
  ds_read_b128 v[180:183], v3 offset:46080
  ds_read_b128 v[184:187], v6 offset:16384
  ds_read_b128 v[188:191], v3 offset:17408
  ds_read_b128 v[192:195], v3 offset:47104
  ds_read_b128 v[196:199], v6 offset:17408
  s_waitcnt lgkmcnt(3)
  v_mfma_f32_32x32x16_bf16 v[16:31], v[176:179], v[128:131], v[16:31]
  v_mfma_f32_32x32x16_bf16 v[32:47], v[180:183], v[128:131], v[32:47]
  v_mfma_f32_32x32x16_bf16 v[48:63], v[128:131], v[184:187], v[48:63]
  ds_read_b128 v[176:179], v3 offset:18432
  ds_read_b128 v[180:183], v3 offset:48128
  ds_read_b128 v[184:187], v6 offset:18432
  s_waitcnt lgkmcnt(3)
  v_mfma_f32_32x32x16_bf16 v[16:31], v[188:191], v[132:135], v[16:31]
  v_mfma_f32_32x32x16_bf16 v[32:47], v[192:195], v[132:135], v[32:47]
  v_mfma_f32_32x32x16_bf16 v[48:63], v[132:135], v[196:199], v[48:63]
  ds_read_b128 v[188:191], v3 offset:19456
  ds_read_b128 v[192:195], v3 offset:49152
  ds_read_b128 v[196:199], v6 offset:19456
  s_waitcnt lgkmcnt(3)
  v_mfma_f32_32x32x16_bf16 v[16:31], v[176:179], v[136:139], v[16:31]
  v_mfma_f32_32x32x16_bf16 v[32:47], v[180:183], v[136:139], v[32:47]
  v_mfma_f32_32x32x16_bf16 v[48:63], v[136:139], v[184:187], v[48:63]
  s_waitcnt lgkmcnt(0)
  v_mfma_f32_32x32x16_bf16 v[16:31], v[188:191], v[140:143], v[16:31]
  v_mfma_f32_32x32x16_bf16 v[32:47], v[192:195], v[140:143], v[32:47]
  v_mfma_f32_32x32x16_bf16 v[48:63], v[140:143], v[196:199], v[48:63]
  s_waitcnt vmcnt(8)
  s_barrier
  ds_read_b128 v[176:179], v3 offset:20480
  ds_read_b128 v[180:183], v3 offset:50176
  ds_read_b128 v[184:187], v6 offset:20480
  ds_read_b128 v[188:191], v3 offset:21504
  ds_read_b128 v[192:195], v3 offset:51200
  ds_read_b128 v[196:199], v6 offset:21504
  s_waitcnt lgkmcnt(3)
  v_mfma_f32_32x32x16_bf16 v[16:31], v[176:179], v[144:147], v[16:31]
  buffer_load_dword v225, v11, s[8:11], s85 offen
  s_add_u32 s85, s85, 3584
  v_mfma_f32_32x32x16_bf16 v[32:47], v[180:183], v[144:147], v[32:47]
  buffer_load_dword v227, v11, s[8:11], s85 offen
  s_add_u32 s85, s85, 3584
  v_mfma_f32_32x32x16_bf16 v[48:63], v[144:147], v[184:187], v[48:63]
  ds_read_b128 v[176:179], v3 offset:22528
  ds_read_b128 v[180:183], v3 offset:52224
  ds_read_b128 v[184:187], v6 offset:22528
  s_waitcnt lgkmcnt(3)
  v_mfma_f32_32x32x16_bf16 v[16:31], v[188:191], v[148:151], v[16:31]
  buffer_load_dword v229, v11, s[8:11], s85 offen
  s_add_u32 s85, s85, 3584
  v_mfma_f32_32x32x16_bf16 v[32:47], v[192:195], v[148:151], v[32:47]
  buffer_load_dword v231, v11, s[8:11], s85 offen
  s_add_u32 s85, s85, 3584
  v_mfma_f32_32x32x16_bf16 v[48:63], v[148:151], v[196:199], v[48:63]
  ds_read_b128 v[188:191], v3 offset:23552
  ds_read_b128 v[192:195], v3 offset:53248
  ds_read_b128 v[196:199], v6 offset:23552
  s_waitcnt lgkmcnt(3)
  v_mfma_f32_32x32x16_bf16 v[16:31], v[176:179], v[152:155], v[16:31]
  buffer_load_dword v233, v11, s[8:11], s85 offen
  s_add_u32 s85, s85, 3584
  v_mfma_f32_32x32x16_bf16 v[32:47], v[180:183], v[152:155], v[32:47]
  buffer_load_dword v235, v11, s[8:11], s85 offen
  s_add_u32 s85, s85, 3584
  v_mfma_f32_32x32x16_bf16 v[48:63], v[152:155], v[184:187], v[48:63]
  s_waitcnt lgkmcnt(0)
  v_mfma_f32_32x32x16_bf16 v[16:31], v[188:191], v[156:159], v[16:31]
  buffer_load_dword v237, v11, s[8:11], s85 offen
  s_add_u32 s85, s85, 3584
  v_mfma_f32_32x32x16_bf16 v[32:47], v[192:195], v[156:159], v[32:47]
  buffer_load_dword v239, v11, s[8:11], s85 offen
  s_add_u32 s85, s85, 3584
  v_mfma_f32_32x32x16_bf16 v[48:63], v[156:159], v[196:199], v[48:63]
  s_waitcnt vmcnt(8)
  s_barrier
  ds_read_b128 v[176:179], v3 offset:24576
  ds_read_b128 v[180:183], v3 offset:54272
  ds_read_b128 v[184:187], v6 offset:24576
  ds_read_b128 v[188:191], v3 offset:25600
  ds_read_b128 v[192:195], v3 offset:55296
  ds_read_b128 v[196:199], v6 offset:25600
  s_waitcnt lgkmcnt(3)
  v_mfma_f32_32x32x16_bf16 v[16:31], v[176:179], v[160:163], v[16:31]
  buffer_load_dword v241, v11, s[8:11], s85 offen
  s_add_u32 s85, s85, 3584
  v_mfma_f32_32x32x16_bf16 v[32:47], v[180:183], v[160:163], v[32:47]
  buffer_load_dword v243, v11, s[8:11], s85 offen
  s_add_u32 s85, s85, 3584
  v_mfma_f32_32x32x16_bf16 v[48:63], v[160:163], v[184:187], v[48:63]
  ds_read_b128 v[176:179], v3 offset:26624
  ds_read_b128 v[180:183], v3 offset:56320
  ds_read_b128 v[184:187], v6 offset:26624
  s_waitcnt lgkmcnt(3)
  v_mfma_f32_32x32x16_bf16 v[16:31], v[188:191], v[164:167], v[16:31]
  buffer_load_dword v245, v11, s[8:11], s85 offen
  s_add_u32 s85, s85, 3584
  v_mfma_f32_32x32x16_bf16 v[32:47], v[192:195], v[164:167], v[32:47]
  buffer_load_dword v247, v11, s[8:11], s85 offen
  s_add_u32 s85, s85, 3584
  v_mfma_f32_32x32x16_bf16 v[48:63], v[164:167], v[196:199], v[48:63]
  ds_read_b128 v[188:191], v3 offset:27648
  ds_read_b128 v[192:195], v3 offset:57344
  ds_read_b128 v[196:199], v6 offset:27648
  s_waitcnt lgkmcnt(3)
  v_mfma_f32_32x32x16_bf16 v[16:31], v[176:179], v[168:171], v[16:31]
  buffer_load_dword v249, v11, s[8:11], s85 offen
  s_add_u32 s85, s85, 3584
  v_mfma_f32_32x32x16_bf16 v[32:47], v[180:183], v[168:171], v[32:47]
  buffer_load_dword v251, v11, s[8:11], s85 offen
  s_add_u32 s85, s85, 3584
  v_mfma_f32_32x32x16_bf16 v[48:63], v[168:171], v[184:187], v[48:63]
  ds_read_b128 v[176:179], v3 offset:28672
  ds_read_b128 v[180:183], v3 offset:58368
  ds_read_b128 v[184:187], v6 offset:28672
  s_waitcnt lgkmcnt(3)
  v_mfma_f32_32x32x16_bf16 v[16:31], v[188:191], v[172:175], v[16:31]
  buffer_load_dword v253, v11, s[8:11], s85 offen
  s_add_u32 s85, s85, 3584
  v_mfma_f32_32x32x16_bf16 v[32:47], v[192:195], v[172:175], v[32:47]
  buffer_load_dword v255, v11, s[8:11], s85 offen
  s_add_u32 s85, s85, 3584
  v_mfma_f32_32x32x16_bf16 v[48:63], v[172:175], v[196:199], v[48:63]
  s_waitcnt lgkmcnt(0)
  v_mfma_f32_32x32x16_bf16 v[16:31], v[176:179], v[200:203], v[16:31]
  v_mfma_f32_32x32x16_bf16 v[32:47], v[180:183], v[200:203], v[32:47]
  v_mfma_f32_32x32x16_bf16 v[48:63], v[200:203], v[184:187], v[48:63]
  s_lshl_b32 s27, s25, 6
  s_add_u32 s27, s27, s26
  s_lshl_b32 s29, s27, 12
  s_add_u32 s29, s29, 5365760
  s_lshl_b32 s30, s25, 10
  s_add_u32 s30, s30, 26861568
  v_and_b32 v5, 31, v1
  v_cmp_eq_u32 vcc, 28, v5
  s_nop 1
  v_cndmask_b32 v6, 0, v200, vcc
  v_cvt_pk_bf16_f32 v16, v16, v17
  v_cvt_pk_bf16_f32 v17, v18, v19
  v_cvt_pk_bf16_f32 v18, v20, v21
  v_cvt_pk_bf16_f32 v19, v22, v23
  v_cvt_pk_bf16_f32 v20, v24, v25
  v_cvt_pk_bf16_f32 v21, v26, v27
  v_cvt_pk_bf16_f32 v22, v28, v29
  v_cvt_pk_bf16_f32 v23, v30, v31
  v_cvt_pk_bf16_f32 v96, v32, v33
  v_cvt_pk_bf16_f32 v97, v34, v35
  v_cvt_pk_bf16_f32 v98, v36, v37
  v_cvt_pk_bf16_f32 v99, v38, v39
  v_cvt_pk_bf16_f32 v100, v40, v41
  v_cvt_pk_bf16_f32 v101, v42, v43
  v_cvt_pk_bf16_f32 v102, v44, v45
  v_cvt_pk_bf16_f32 v103, v46, v47
  s_mov_b32 exec_lo, 0
  v_mov_b32 v22, 0
  v_mov_b32 v23, 0
  v_mov_b32 v102, s50
  v_mov_b32 v103, 0x3f80
  s_mov_b64 exec, -1
  s_nop 0
  v_mfma_f32_32x32x16_bf16 v[64:79], v[96:99], v[16:19], 0
  v_mfma_f32_32x32x16_bf16 v[64:79], v[100:103], v[20:23], v[64:79]
  buffer_store_dwordx4 v[96:99], v3, s[20:23], s29 offen sc1
  buffer_store_dwordx4 v[100:103], v3, s[20:23], s29 offen offset:1024 sc1
  v_cvt_pk_bf16_f32 v104, v48, v49
  v_cvt_pk_bf16_f32 v105, v50, v51
  v_cvt_pk_bf16_f32 v106, v52, v53
  v_cvt_pk_bf16_f32 v107, v54, v55
  v_cvt_pk_bf16_f32 v108, v56, v57
  v_cvt_pk_bf16_f32 v109, v58, v59
  v_cvt_pk_bf16_f32 v110, v60, v61
  v_cvt_pk_bf16_f32 v111, v62, v63
  s_mov_b32 exec_lo, 0xf0000000
  s_mov_b32 exec_hi, 0xf0000000
  v_mov_b32 v104, v6
  v_mov_b32 v105, v6
  v_mov_b32 v106, v6
  v_mov_b32 v107, v6
  v_mov_b32 v108, v6
  v_mov_b32 v109, v6
  v_mov_b32 v110, v6
  v_mov_b32 v111, v6
  s_mov_b64 exec, -1
  buffer_store_dwordx4 v[104:107], v3, s[20:23], s29 offen offset:2048 sc1
  buffer_store_dwordx4 v[108:111], v3, s[20:23], s29 offen offset:3072 sc1
  buffer_load_dwordx4 v[160:163], v9, s[20:23], s84 offen offset:0
  buffer_load_dwordx4 v[192:195], v9, s[20:23], s84 offen offset:1792
  buffer_load_dwordx4 v[164:167], v9, s[20:23], s84 offen offset:16
  buffer_load_dwordx4 v[196:199], v9, s[20:23], s84 offen offset:1808
  buffer_load_dwordx4 v[168:171], v9, s[20:23], s84 offen offset:32
  buffer_load_dwordx4 v[200:203], v9, s[20:23], s84 offen offset:1824
  buffer_load_dwordx4 v[172:175], v9, s[20:23], s84 offen offset:48
  buffer_load_dwordx4 v[204:207], v9, s[20:23], s84 offen offset:1840
  v_max3_f32 v80, v64, v65, v66
  v_max3_f32 v81, v67, v68, v69
  v_max3_f32 v80, v80, v70, v71
  v_max3_f32 v81, v81, v72, v73
  v_max3_f32 v80, v80, v74, v75
  v_max3_f32 v81, v81, v76, v77
  v_max3_f32 v80, v80, v78, v79
  v_max_f32 v80, v80, v81
  v_mov_b32 v81, v80
  s_nop 1
  v_permlane32_swap_b32 v80, v81
  v_max_f32 v80, v80, v81
  s_mov_b32 exec_lo, 0
  v_cvt_pk_bf16_f32 v81, -v80, -v80
  v_and_b32 v81, s34, v81
  v_sub_f32 v82, -v80, v81
  v_cvt_pk_bf16_f32 v83, v82, v82
  v_and_b32 v83, s34, v83
  v_sub_f32 v82, v82, v83
  v_cvt_pk_bf16_f32 v22, v81, v83
  v_cvt_pk_bf16_f32 v23, v82, 0
  s_mov_b64 exec, -1
  s_lshl_b32 s36, s24, 11
  s_add_u32 s36, s36, 98304
  v_add_u32 v4, s36, v3
  ds_write_b128 v4, v[16:19]
  ds_write_b128 v4, v[20:23] offset:1024
  s_lshr_b32 s26, s26, 2
  s_lshl_b32 s39, s25, 18
  s_lshl_b32 s36, s24, 12
  s_add_u32 s39, s39, s36
  s_add_u32 s39, s39, 5365760
  v_add_u32 v15, s39, v3
  s_lshl_b32 s39, s26, 14
  s_mov_b32 s70, 0
  s_add_u32 s36, s24, 1
  s_and_b32 s36, s36, 3
  s_mul_i32 s40, s36, 3
  s_add_u32 s40, s40, 0
  s_lshl_b32 s40, s40, 12
  s_add_u32 s40, s40, 114688
  s_lshl_b32 s36, s36, 11
  s_add_u32 s36, s36, 98304
  v_add_u32 v85, s36, v3
  s_add_u32 s36, s24, 2
  s_and_b32 s36, s36, 3
  s_mul_i32 s41, s36, 3
  s_add_u32 s41, s41, 1
  s_lshl_b32 s41, s41, 12
  s_add_u32 s41, s41, 114688
  s_lshl_b32 s36, s36, 11
  s_add_u32 s36, s36, 98304
  v_add_u32 v86, s36, v3
  s_add_u32 s36, s24, 3
  s_and_b32 s36, s36, 3
  s_mul_i32 s42, s36, 3
  s_add_u32 s42, s42, 2
  s_lshl_b32 s42, s42, 12
  s_add_u32 s42, s42, 114688
  s_lshl_b32 s36, s36, 11
  s_add_u32 s36, s36, 98304
  v_add_u32 v87, s36, v3
  s_mul_i32 s43, s24, 12288
  s_add_u32 s43, s43, 114688
  s_waitcnt lgkmcnt(0)
  s_mov_b32 s66, s26
  s_lshl_b32 s66, s66, 2
  s_add_u32 s66, s66, s30
  v_lshlrev_b32 v4, 8, v1
  v_mov_b32 v5, 0x5a17c0de
  s_waitcnt vmcnt(8)
  s_barrier
  s_cmp_lg_u32 s24, 0
  s_cbranch_scc1 Lsig1
  s_mov_b64 exec, 0xf
  buffer_store_dword v5, v4, s[20:23], s66 offen sc1
  s_mov_b64 exec, -1
Lsig1:
  ds_read_b128 v[24:27], v85
  ds_read_b128 v[28:31], v85 offset:1024
  ds_read_b128 v[32:35], v86
  ds_read_b128 v[36:39], v86 offset:1024
  ds_read_b128 v[40:43], v87
  ds_read_b128 v[44:47], v87 offset:1024
  s_mul_i32 s79, s61, 9363
  s_lshr_b32 s79, s79, 16
  s_mul_i32 s80, s79, 7
  s_sub_u32 s80, s61, s80
  s_lshl_b32 s81, s60, 2
  s_add_u32 s81, s81, s79
  s_lshl_b32 s67, s81, 1
  s_lshl_b32 s68, s80, 1
  s_lshr_b32 s69, s81, 1
  s_and_b32 s79, s24, 1
  s_add_u32 s72, s68, s79
  s_xor_b32 s73, s72, 1
  s_lshl_b32 s79, s79, 14
  s_add_u32 s79, s79, 11657216
  s_lshl_b32 s74, s72, 15
  s_lshl_b32 s75, s73, 15
  s_add_u32 s74, s74, s79
  s_add_u32 s75, s75, s79
  s_mul_i32 s79, s24, 28672
  s_add_u32 s79, s79, 25255936
  s_mul_i32 s76, s72, 114688
  s_mul_i32 s77, s73, 114688
  s_add_u32 s76, s76, s79
  s_add_u32 s77, s77, s79
  s_cmp_ge_u32 s61, 28
  s_cmov_b32 s74, 1073741824
  s_cmov_b32 s75, 1073741824
  s_cmov_b32 s76, 1073741824
  s_cmov_b32 s77, 1073741824
  s_lshl_b32 s55, s60, 1
  s_lshr_b32 s79, s61, 4
  s_add_u32 s55, s55, s79
  s_and_b32 s56, s61, 15
  s_mul_i32 s57, s56, 200704
  s_mul_i32 s58, s24, 7168
  s_add_u32 s57, s57, s58
  s_add_u32 s57, s57, 13950976
  s_mul_i32 s87, s56, 7
  s_lshr_b32 s87, s87, 2
  v_bfe_u32 v8, v1, 2, 2
  v_min_u32 v8, 2, v8
  v_add_u32 v8, s87, v8
  v_min_u32 v8, 27, v8
  v_bfe_u32 v10, v1, 4, 1
  v_mul_u32_u24 v10, 28, v10
  v_add_u32 v8, v8, v10
  v_lshlrev_b32 v8, 6, v8
  v_and_b32 v10, 3, v1
  v_lshl_add_u32 v8, v10, 4, v8
  s_mov_b32 s87, 26959872
  s_lshr_b32 s79, s24, 1
  s_add_u32 s38, s67, s79
  v_and_b32 v10, 31, v1
  s_lshl_b32 s79, s38, 5
  v_add_u32 v10, s79, v10
  v_mul_u32_u24 v10, 896, v10
  v_lshl_add_u32 v10, v7, 5, v10
  s_lshl_b32 s53, s72, 6
  v_lshlrev_b32 v11, 4, v7
  s_lshl_b32 s54, s72, 7
  s_add_u32 s54, s54, 3264000
  v_mov_b32 v9, 0x5a17c0de
  s_mul_i32 s59, s56, 1792
  s_add_u32 s59, s59, 17162240
  v_lshlrev_b32 v14, 3, v0
  s_cmp_ge_u32 s78, 784
  s_cbranch_scc1 S1_e
  v_mov_b32 v48, 0
  v_mov_b32 v49, 0
  v_mov_b32 v50, 0
  v_mov_b32 v51, 0
  s_waitcnt vmcnt(0)
  v_lshlrev_b32 v224, 16, v225
  v_and_b32 v225, s34, v225
  v_pk_fma_f32 v[48:49], v[224:225], v[160:161], v[48:49] op_sel_hi:[1,0,1]
  v_pk_mul_f32 v[224:225], v[224:225], v[192:193] op_sel_hi:[1,0]
  v_lshlrev_b32 v226, 16, v227
  v_and_b32 v227, s34, v227
  v_pk_fma_f32 v[50:51], v[226:227], v[160:161], v[50:51] op_sel:[0,1,0] op_sel_hi:[1,1,1]
  v_pk_mul_f32 v[226:227], v[226:227], v[192:193] op_sel:[0,1] op_sel_hi:[1,1]
  v_lshlrev_b32 v228, 16, v229
  v_and_b32 v229, s34, v229
  v_pk_fma_f32 v[48:49], v[228:229], v[162:163], v[48:49] op_sel_hi:[1,0,1]
  v_pk_mul_f32 v[228:229], v[228:229], v[194:195] op_sel_hi:[1,0]
  v_lshlrev_b32 v230, 16, v231
  v_and_b32 v231, s34, v231
  v_pk_fma_f32 v[50:51], v[230:231], v[162:163], v[50:51] op_sel:[0,1,0] op_sel_hi:[1,1,1]
  v_pk_mul_f32 v[230:231], v[230:231], v[194:195] op_sel:[0,1] op_sel_hi:[1,1]
  v_lshlrev_b32 v232, 16, v233
  v_and_b32 v233, s34, v233
  v_pk_fma_f32 v[48:49], v[232:233], v[164:165], v[48:49] op_sel_hi:[1,0,1]
  v_pk_mul_f32 v[232:233], v[232:233], v[196:197] op_sel_hi:[1,0]
  v_lshlrev_b32 v234, 16, v235
  v_and_b32 v235, s34, v235
  v_pk_fma_f32 v[50:51], v[234:235], v[164:165], v[50:51] op_sel:[0,1,0] op_sel_hi:[1,1,1]
  v_pk_mul_f32 v[234:235], v[234:235], v[196:197] op_sel:[0,1] op_sel_hi:[1,1]
  v_lshlrev_b32 v236, 16, v237
  v_and_b32 v237, s34, v237
  v_pk_fma_f32 v[48:49], v[236:237], v[166:167], v[48:49] op_sel_hi:[1,0,1]
  v_pk_mul_f32 v[236:237], v[236:237], v[198:199] op_sel_hi:[1,0]
  v_lshlrev_b32 v238, 16, v239
  v_and_b32 v239, s34, v239
  v_pk_fma_f32 v[50:51], v[238:239], v[166:167], v[50:51] op_sel:[0,1,0] op_sel_hi:[1,1,1]
  v_pk_mul_f32 v[238:239], v[238:239], v[198:199] op_sel:[0,1] op_sel_hi:[1,1]
  v_lshlrev_b32 v240, 16, v241
  v_and_b32 v241, s34, v241
  v_pk_fma_f32 v[48:49], v[240:241], v[168:169], v[48:49] op_sel_hi:[1,0,1]
  v_pk_mul_f32 v[240:241], v[240:241], v[200:201] op_sel_hi:[1,0]
  v_lshlrev_b32 v242, 16, v243
  v_and_b32 v243, s34, v243
  v_pk_fma_f32 v[50:51], v[242:243], v[168:169], v[50:51] op_sel:[0,1,0] op_sel_hi:[1,1,1]
  v_pk_mul_f32 v[242:243], v[242:243], v[200:201] op_sel:[0,1] op_sel_hi:[1,1]
  v_lshlrev_b32 v244, 16, v245
  v_and_b32 v245, s34, v245
  v_pk_fma_f32 v[48:49], v[244:245], v[170:171], v[48:49] op_sel_hi:[1,0,1]
  v_pk_mul_f32 v[244:245], v[244:245], v[202:203] op_sel_hi:[1,0]
  v_lshlrev_b32 v246, 16, v247
  v_and_b32 v247, s34, v247
  v_pk_fma_f32 v[50:51], v[246:247], v[170:171], v[50:51] op_sel:[0,1,0] op_sel_hi:[1,1,1]
  v_pk_mul_f32 v[246:247], v[246:247], v[202:203] op_sel:[0,1] op_sel_hi:[1,1]
  v_lshlrev_b32 v248, 16, v249
  v_and_b32 v249, s34, v249
  v_pk_fma_f32 v[48:49], v[248:249], v[172:173], v[48:49] op_sel_hi:[1,0,1]
  v_pk_mul_f32 v[248:249], v[248:249], v[204:205] op_sel_hi:[1,0]
  v_lshlrev_b32 v250, 16, v251
  v_and_b32 v251, s34, v251
  v_pk_fma_f32 v[50:51], v[250:251], v[172:173], v[50:51] op_sel:[0,1,0] op_sel_hi:[1,1,1]
  v_pk_mul_f32 v[250:251], v[250:251], v[204:205] op_sel:[0,1] op_sel_hi:[1,1]
  v_lshlrev_b32 v252, 16, v253
  v_and_b32 v253, s34, v253
  v_pk_fma_f32 v[48:49], v[252:253], v[174:175], v[48:49] op_sel_hi:[1,0,1]
  v_pk_mul_f32 v[252:253], v[252:253], v[206:207] op_sel_hi:[1,0]
  v_lshlrev_b32 v254, 16, v255
  v_and_b32 v255, s34, v255
  v_pk_fma_f32 v[50:51], v[254:255], v[174:175], v[50:51] op_sel:[0,1,0] op_sel_hi:[1,1,1]
  v_pk_mul_f32 v[254:255], v[254:255], v[206:207] op_sel:[0,1] op_sel_hi:[1,1]
  v_cvt_pk_bf16_f32 v176, v224, v226
  v_cvt_pk_bf16_f32 v177, v228, v230
  v_cvt_pk_bf16_f32 v178, v240, v242
  v_cvt_pk_bf16_f32 v179, v244, v246
  v_cvt_pk_bf16_f32 v180, v225, v227
  v_cvt_pk_bf16_f32 v181, v229, v231
  v_cvt_pk_bf16_f32 v182, v241, v243
  v_cvt_pk_bf16_f32 v183, v245, v247
  v_cvt_pk_bf16_f32 v184, v232, v234
  v_cvt_pk_bf16_f32 v185, v236, v238
  v_cvt_pk_bf16_f32 v186, v248, v250
  v_cvt_pk_bf16_f32 v187, v252, v254
  v_cvt_pk_bf16_f32 v188, v233, v235
  v_cvt_pk_bf16_f32 v189, v237, v239
  v_cvt_pk_bf16_f32 v190, v249, v251
  v_cvt_pk_bf16_f32 v191, v253, v255
  v_pk_add_f32 v[48:49], v[48:49], v[50:51]
  v_mov_b32 v50, 0
  v_mov_b32 v51, 0
  v_dot2c_f32_bf16 v50, s50, v176
  v_dot2c_f32_bf16 v51, s50, v180
  v_dot2c_f32_bf16 v50, s50, v177
  v_dot2c_f32_bf16 v51, s50, v181
  v_dot2c_f32_bf16 v50, s50, v178
  v_dot2c_f32_bf16 v51, s50, v182
  v_dot2c_f32_bf16 v50, s50, v179
  v_dot2c_f32_bf16 v51, s50, v183
  v_dot2c_f32_bf16 v50, s50, v184
  v_dot2c_f32_bf16 v51, s50, v188
  v_dot2c_f32_bf16 v50, s50, v185
  v_dot2c_f32_bf16 v51, s50, v189
  v_dot2c_f32_bf16 v50, s50, v186
  v_dot2c_f32_bf16 v51, s50, v190
  v_dot2c_f32_bf16 v50, s50, v187
  v_dot2c_f32_bf16 v51, s50, v191
  v_mov_b32 v208, v180
  v_mov_b32 v209, v181
  v_mov_b32 v210, v182
  v_mov_b32 v211, v183
  v_mov_b32_dpp v180, v176 row_shl:4 row_mask:0xf bank_mask:0x5
  v_mov_b32_dpp v181, v177 row_shl:4 row_mask:0xf bank_mask:0x5
  v_mov_b32_dpp v182, v178 row_shl:4 row_mask:0xf bank_mask:0x5
  v_mov_b32_dpp v183, v179 row_shl:4 row_mask:0xf bank_mask:0x5
  v_mov_b32_dpp v176, v208 row_shr:4 row_mask:0xf bank_mask:0xa
  v_mov_b32_dpp v177, v209 row_shr:4 row_mask:0xf bank_mask:0xa
  v_mov_b32_dpp v178, v210 row_shr:4 row_mask:0xf bank_mask:0xa
  v_mov_b32_dpp v179, v211 row_shr:4 row_mask:0xf bank_mask:0xa
  buffer_store_dwordx4 v[176:179], v13, s[20:23], s82 offen offset:0 sc1
  buffer_store_dwordx4 v[180:183], v13, s[20:23], s82 offen offset:128 sc1
  v_mov_b32 v208, v188
  v_mov_b32 v209, v189
  v_mov_b32 v210, v190
  v_mov_b32 v211, v191
  v_mov_b32_dpp v188, v184 row_shl:4 row_mask:0xf bank_mask:0x5
  v_mov_b32_dpp v189, v185 row_shl:4 row_mask:0xf bank_mask:0x5
  v_mov_b32_dpp v190, v186 row_shl:4 row_mask:0xf bank_mask:0x5
  v_mov_b32_dpp v191, v187 row_shl:4 row_mask:0xf bank_mask:0x5
  v_mov_b32_dpp v184, v208 row_shr:4 row_mask:0xf bank_mask:0xa
  v_mov_b32_dpp v185, v209 row_shr:4 row_mask:0xf bank_mask:0xa
  v_mov_b32_dpp v186, v210 row_shr:4 row_mask:0xf bank_mask:0xa
  v_mov_b32_dpp v187, v211 row_shr:4 row_mask:0xf bank_mask:0xa
  buffer_store_dwordx4 v[184:187], v13, s[20:23], s82 offen offset:512 sc1
  buffer_store_dwordx4 v[188:191], v13, s[20:23], s82 offen offset:640 sc1
  v_permlane32_swap_b32 v48, v49
  v_permlane32_swap_b32 v50, v51
  v_add_f32 v212, v48, v49
  v_add_f32 v213, v50, v51
  buffer_store_dwordx2 v[212:213], v12, s[20:23], s83 offen sc1
S1_e:
  s_waitcnt lgkmcnt(0)
  v_mfma_f32_32x32x16_bf16 v[48:63], v[96:99], v[16:19], 0
  v_mfma_f32_32x32x16_bf16 v[48:63], v[100:103], v[20:23], v[48:63]
  s_cmp_lg_u32 s24, 3
  s_cbranch_scc1 Lpd3
  s_add_u32 s66, s30, s63
  v_lshl_add_u32 v4, v1, 2, s66
  s_mov_b64 exec, 0xffff
  v_mov_b32 v6, 0x5a17c0de
  s_mov_b32 s66, 0
Lpoll2:
  buffer_load_dword v5, v4, s[20:23], 0 offen sc1
  s_add_u32 s66, s66, 1
  s_waitcnt vmcnt(0)
  v_cmp_ne_u32 vcc, v6, v5
  s_cmp_gt_u32 s66, 400000
  s_cbranch_scc1 Lpoll2x
  s_cmp_lg_u64 vcc, 0
  s_cbranch_scc1 Lpoll2
Lpoll2x:
  s_mov_b64 exec, -1
Lpd3:
  s_barrier
B_restart:
  s_or_b32 s36, s39, 0xc000
  s_add_u32 s36, s36, 0x4000
  s_and_b32 s36, s36, 0x3ffff
  buffer_load_dwordx4 v[112:115], v15, s[20:23], s36 offen sc1
  buffer_load_dwordx4 v[116:119], v15, s[20:23], s36 offen offset:1024 sc1
  buffer_load_dwordx4 v[120:123], v15, s[20:23], s36 offen offset:2048 sc1
  buffer_load_dwordx4 v[124:127], v15, s[20:23], s36 offen offset:3072 sc1
  s_add_u32 s36, s36, 0x4000
  s_and_b32 s36, s36, 0x3ffff
  buffer_load_dwordx4 v[128:131], v15, s[20:23], s36 offen sc1
  buffer_load_dwordx4 v[132:135], v15, s[20:23], s36 offen offset:1024 sc1
  v_mfma_f32_32x32x16_bf16 v[64:79], v[96:99], v[24:27], 0
  v_exp_f32 v48, v48
  v_exp_f32 v49, v49
  v_exp_f32 v50, v50
  v_exp_f32 v51, v51
  v_cvt_pk_bf16_f32 v80, v48, v49
  v_cvt_pk_bf16_f32 v81, v50, v51
  v_mfma_f32_32x32x16_bf16 v[64:79], v[100:103], v[28:31], v[64:79]
  buffer_load_dwordx4 v[136:139], v15, s[20:23], s36 offen offset:2048 sc1
  buffer_load_dwordx4 v[140:143], v15, s[20:23], s36 offen offset:3072 sc1
  v_exp_f32 v52, v52
  v_exp_f32 v53, v53
  v_exp_f32 v54, v54
  v_exp_f32 v55, v55
  v_cvt_pk_bf16_f32 v82, v52, v53
  v_cvt_pk_bf16_f32 v83, v54, v55
  v_exp_f32 v56, v56
  v_exp_f32 v57, v57
  v_exp_f32 v58, v58
  v_exp_f32 v59, v59
  v_cvt_pk_bf16_f32 v84, v56, v57
  v_cvt_pk_bf16_f32 v85, v58, v59
  s_add_u32 s36, s36, 0x4000
  s_and_b32 s36, s36, 0x3ffff
  buffer_load_dwordx4 v[144:147], v15, s[20:23], s36 offen sc1
  buffer_load_dwordx4 v[148:151], v15, s[20:23], s36 offen offset:1024 sc1
  v_exp_f32 v60, v60
  v_exp_f32 v61, v61
  v_exp_f32 v62, v62
  v_exp_f32 v63, v63
  v_cvt_pk_bf16_f32 v86, v60, v61
  v_cvt_pk_bf16_f32 v87, v62, v63
  v_mfma_f32_32x32x16_bf16 v[48:63], v[96:99], v[32:35], 0
  v_exp_f32 v64, v64
  v_exp_f32 v65, v65
  v_exp_f32 v66, v66
  v_exp_f32 v67, v67
  v_cvt_pk_bf16_f32 v88, v64, v65
  v_cvt_pk_bf16_f32 v89, v66, v67
  v_mfma_f32_32x32x16_bf16 v[48:63], v[100:103], v[36:39], v[48:63]
  buffer_load_dwordx4 v[152:155], v15, s[20:23], s36 offen offset:2048 sc1
  buffer_load_dwordx4 v[156:159], v15, s[20:23], s36 offen offset:3072 sc1
  v_exp_f32 v68, v68
  v_exp_f32 v69, v69
  v_exp_f32 v70, v70
  v_exp_f32 v71, v71
  v_cvt_pk_bf16_f32 v90, v68, v69
  v_cvt_pk_bf16_f32 v91, v70, v71
  v_mfma_f32_32x32x16_bf16 a[0:15], v[104:107], v[80:83], 0
  v_exp_f32 v72, v72
  v_exp_f32 v73, v73
  v_exp_f32 v74, v74
  v_exp_f32 v75, v75
  v_cvt_pk_bf16_f32 v92, v72, v73
  v_cvt_pk_bf16_f32 v93, v74, v75
  v_mfma_f32_32x32x16_bf16 a[0:15], v[108:111], v[84:87], a[0:15]
  v_exp_f32 v76, v76
  v_exp_f32 v77, v77
  v_exp_f32 v78, v78
  v_exp_f32 v79, v79
  v_cvt_pk_bf16_f32 v94, v76, v77
  v_cvt_pk_bf16_f32 v95, v78, v79
  v_mfma_f32_32x32x16_bf16 v[64:79], v[96:99], v[40:43], 0
  v_exp_f32 v48, v48
  v_exp_f32 v49, v49
  v_exp_f32 v50, v50
  v_exp_f32 v51, v51
  v_cvt_pk_bf16_f32 v80, v48, v49
  v_cvt_pk_bf16_f32 v81, v50, v51
  v_mfma_f32_32x32x16_bf16 v[64:79], v[100:103], v[44:47], v[64:79]
  v_exp_f32 v52, v52
  v_exp_f32 v53, v53
  v_exp_f32 v54, v54
  v_exp_f32 v55, v55
  v_cvt_pk_bf16_f32 v82, v52, v53
  v_cvt_pk_bf16_f32 v83, v54, v55
  v_mfma_f32_32x32x16_bf16 a[16:31], v[104:107], v[88:91], 0
  v_exp_f32 v56, v56
  v_exp_f32 v57, v57
  v_exp_f32 v58, v58
  v_exp_f32 v59, v59
  v_cvt_pk_bf16_f32 v84, v56, v57
  v_cvt_pk_bf16_f32 v85, v58, v59
  v_mfma_f32_32x32x16_bf16 a[16:31], v[108:111], v[92:95], a[16:31]
  v_exp_f32 v60, v60
  v_exp_f32 v61, v61
  v_exp_f32 v62, v62
  v_exp_f32 v63, v63
  s_waitcnt vmcnt(10)
  v_cvt_pk_bf16_f32 v86, v60, v61
  v_cvt_pk_bf16_f32 v87, v62, v63
  v_mfma_f32_32x32x16_bf16 v[48:63], v[112:115], v[16:19], 0
  s_mov_b64 exec, 1
  buffer_store_dword v9, off, s[20:23], s86 sc1
  s_mov_b64 exec, -1
  s_mov_b32 s86, 1073741824
  s_add_u32 s36, s36, 0x4000
  s_and_b32 s36, s36, 0x3ffff
  buffer_load_dwordx4 v[96:99], v15, s[20:23], s36 offen sc1
  buffer_load_dwordx4 v[100:103], v15, s[20:23], s36 offen offset:1024 sc1
  v_exp_f32 v64, v64
  v_exp_f32 v65, v65
  v_exp_f32 v66, v66
  v_exp_f32 v67, v67
  v_cvt_pk_bf16_f32 v88, v64, v65
  v_cvt_pk_bf16_f32 v89, v66, v67
  v_mfma_f32_32x32x16_bf16 v[48:63], v[116:119], v[20:23], v[48:63]
  v_exp_f32 v68, v68
  v_exp_f32 v69, v69
  v_exp_f32 v70, v70
  v_exp_f32 v71, v71
  v_cvt_pk_bf16_f32 v90, v68, v69
  v_cvt_pk_bf16_f32 v91, v70, v71
  v_mfma_f32_32x32x16_bf16 a[32:47], v[104:107], v[80:83], 0
  v_exp_f32 v72, v72
  v_exp_f32 v73, v73
  v_exp_f32 v74, v74
  v_exp_f32 v75, v75
  v_cvt_pk_bf16_f32 v92, v72, v73
  v_cvt_pk_bf16_f32 v93, v74, v75
  v_mfma_f32_32x32x16_bf16 a[32:47], v[108:111], v[84:87], a[32:47]
  v_exp_f32 v76, v76
  v_exp_f32 v77, v77
  v_exp_f32 v78, v78
  v_exp_f32 v79, v79
  v_cvt_pk_bf16_f32 v94, v76, v77
  v_cvt_pk_bf16_f32 v95, v78, v79
  v_mfma_f32_32x32x16_bf16 v[64:79], v[112:115], v[24:27], 0
  v_exp_f32 v48, v48
  v_exp_f32 v49, v49
  v_exp_f32 v50, v50
  v_exp_f32 v51, v51
  v_cvt_pk_bf16_f32 v80, v48, v49
  v_cvt_pk_bf16_f32 v81, v50, v51
  v_mfma_f32_32x32x16_bf16 v[64:79], v[116:119], v[28:31], v[64:79]
  s_add_u32 s80, s74, 0
  buffer_load_dwordx4 v[160:163], v3, s[20:23], s80 offen offset:0
  v_exp_f32 v52, v52
  v_exp_f32 v53, v53
  v_exp_f32 v54, v54
  v_exp_f32 v55, v55
  v_cvt_pk_bf16_f32 v82, v52, v53
  v_cvt_pk_bf16_f32 v83, v54, v55
  v_mfma_f32_32x32x16_bf16 a[48:63], v[104:107], v[88:91], 0
  v_exp_f32 v56, v56
  v_exp_f32 v57, v57
  v_exp_f32 v58, v58
  v_exp_f32 v59, v59
  v_cvt_pk_bf16_f32 v84, v56, v57
  v_cvt_pk_bf16_f32 v85, v58, v59
  v_mfma_f32_32x32x16_bf16 a[48:63], v[108:111], v[92:95], a[48:63]
  buffer_load_dwordx4 v[164:167], v3, s[20:23], s80 offen offset:1024
  v_exp_f32 v60, v60
  v_exp_f32 v61, v61
  v_exp_f32 v62, v62
  v_exp_f32 v63, v63
  v_cvt_pk_bf16_f32 v86, v60, v61
  v_cvt_pk_bf16_f32 v87, v62, v63
  v_mfma_f32_32x32x16_bf16 v[48:63], v[112:115], v[32:35], 0
  buffer_load_dwordx4 v[168:171], v3, s[20:23], s80 offen offset:2048
  v_exp_f32 v64, v64
  v_exp_f32 v65, v65
  v_exp_f32 v66, v66
  v_exp_f32 v67, v67
  v_cvt_pk_bf16_f32 v88, v64, v65
  v_cvt_pk_bf16_f32 v89, v66, v67
  v_mfma_f32_32x32x16_bf16 v[48:63], v[116:119], v[36:39], v[48:63]
  v_exp_f32 v68, v68
  v_exp_f32 v69, v69
  v_exp_f32 v70, v70
  v_exp_f32 v71, v71
  s_waitcnt vmcnt(14)
  v_cvt_pk_bf16_f32 v90, v68, v69
  v_cvt_pk_bf16_f32 v91, v70, v71
  v_mfma_f32_32x32x16_bf16 a[0:15], v[120:123], v[80:83], a[0:15]
  buffer_load_dwordx4 v[104:107], v15, s[20:23], s36 offen offset:2048 sc1
  buffer_load_dwordx4 v[108:111], v15, s[20:23], s36 offen offset:3072 sc1
  v_exp_f32 v72, v72
  v_exp_f32 v73, v73
  v_exp_f32 v74, v74
  v_exp_f32 v75, v75
  v_cvt_pk_bf16_f32 v92, v72, v73
  v_cvt_pk_bf16_f32 v93, v74, v75
  v_mfma_f32_32x32x16_bf16 a[0:15], v[124:127], v[84:87], a[0:15]
  v_exp_f32 v76, v76
  v_exp_f32 v77, v77
  v_exp_f32 v78, v78
  v_exp_f32 v79, v79
  v_cvt_pk_bf16_f32 v94, v76, v77
  v_cvt_pk_bf16_f32 v95, v78, v79
  v_mfma_f32_32x32x16_bf16 v[64:79], v[112:115], v[40:43], 0
  buffer_load_dwordx4 v[172:175], v3, s[20:23], s80 offen offset:3072
  v_exp_f32 v48, v48
  v_exp_f32 v49, v49
  v_exp_f32 v50, v50
  v_exp_f32 v51, v51
  v_cvt_pk_bf16_f32 v80, v48, v49
  v_cvt_pk_bf16_f32 v81, v50, v51
  v_mfma_f32_32x32x16_bf16 v[64:79], v[116:119], v[44:47], v[64:79]
  v_exp_f32 v52, v52
  v_exp_f32 v53, v53
  v_exp_f32 v54, v54
  v_exp_f32 v55, v55
  v_cvt_pk_bf16_f32 v82, v52, v53
  v_cvt_pk_bf16_f32 v83, v54, v55
  v_mfma_f32_32x32x16_bf16 a[16:31], v[120:123], v[88:91], a[16:31]
  s_add_u32 s80, s74, 4096
  buffer_load_dwordx4 v[176:179], v3, s[20:23], s80 offen offset:0
  v_exp_f32 v56, v56
  v_exp_f32 v57, v57
  v_exp_f32 v58, v58
  v_exp_f32 v59, v59
  v_cvt_pk_bf16_f32 v84, v56, v57
  v_cvt_pk_bf16_f32 v85, v58, v59
  v_mfma_f32_32x32x16_bf16 a[16:31], v[124:127], v[92:95], a[16:31]
  v_exp_f32 v60, v60
  v_exp_f32 v61, v61
  v_exp_f32 v62, v62
  v_exp_f32 v63, v63
  s_waitcnt vmcnt(16)
  v_cvt_pk_bf16_f32 v86, v60, v61
  v_cvt_pk_bf16_f32 v87, v62, v63
  v_mfma_f32_32x32x16_bf16 v[48:63], v[128:131], v[16:19], 0
  s_add_u32 s36, s36, 0x4000
  s_and_b32 s36, s36, 0x3ffff
  buffer_load_dwordx4 v[112:115], v15, s[20:23], s36 offen sc1
  buffer_load_dwordx4 v[116:119], v15, s[20:23], s36 offen offset:1024 sc1
  v_exp_f32 v64, v64
  v_exp_f32 v65, v65
  v_exp_f32 v66, v66
  v_exp_f32 v67, v67
  v_cvt_pk_bf16_f32 v88, v64, v65
  v_cvt_pk_bf16_f32 v89, v66, v67
  v_mfma_f32_32x32x16_bf16 v[48:63], v[132:135], v[20:23], v[48:63]
  buffer_load_dwordx4 v[180:183], v3, s[20:23], s80 offen offset:1024
  v_exp_f32 v68, v68
  v_exp_f32 v69, v69
  v_exp_f32 v70, v70
  v_exp_f32 v71, v71
  v_cvt_pk_bf16_f32 v90, v68, v69
  v_cvt_pk_bf16_f32 v91, v70, v71
  v_mfma_f32_32x32x16_bf16 a[32:47], v[120:123], v[80:83], a[32:47]
  v_exp_f32 v72, v72
  v_exp_f32 v73, v73
  v_exp_f32 v74, v74
  v_exp_f32 v75, v75
  v_cvt_pk_bf16_f32 v92, v72, v73
  v_cvt_pk_bf16_f32 v93, v74, v75
  v_mfma_f32_32x32x16_bf16 a[32:47], v[124:127], v[84:87], a[32:47]
  buffer_load_dwordx4 v[184:187], v3, s[20:23], s80 offen offset:2048
  v_exp_f32 v76, v76
  v_exp_f32 v77, v77
  v_exp_f32 v78, v78
  v_exp_f32 v79, v79
  v_cvt_pk_bf16_f32 v94, v76, v77
  v_cvt_pk_bf16_f32 v95, v78, v79
  v_mfma_f32_32x32x16_bf16 v[64:79], v[128:131], v[24:27], 0
  v_exp_f32 v48, v48
  v_exp_f32 v49, v49
  v_exp_f32 v50, v50
  v_exp_f32 v51, v51
  v_cvt_pk_bf16_f32 v80, v48, v49
  v_cvt_pk_bf16_f32 v81, v50, v51
  v_mfma_f32_32x32x16_bf16 v[64:79], v[132:135], v[28:31], v[64:79]
  buffer_load_dwordx4 v[188:191], v3, s[20:23], s80 offen offset:3072
  v_exp_f32 v52, v52
  v_exp_f32 v53, v53
  v_exp_f32 v54, v54
  v_exp_f32 v55, v55
  v_cvt_pk_bf16_f32 v82, v52, v53
  v_cvt_pk_bf16_f32 v83, v54, v55
  v_mfma_f32_32x32x16_bf16 a[48:63], v[120:123], v[88:91], a[48:63]
  v_exp_f32 v56, v56
  v_exp_f32 v57, v57
  v_exp_f32 v58, v58
  v_exp_f32 v59, v59
  v_cvt_pk_bf16_f32 v84, v56, v57
  v_cvt_pk_bf16_f32 v85, v58, v59
  v_mfma_f32_32x32x16_bf16 a[48:63], v[124:127], v[92:95], a[48:63]
  s_add_u32 s80, s74, 8192
  buffer_load_dwordx4 v[192:195], v3, s[20:23], s80 offen offset:0
  v_exp_f32 v60, v60
  v_exp_f32 v61, v61
  v_exp_f32 v62, v62
  v_exp_f32 v63, v63
  v_cvt_pk_bf16_f32 v86, v60, v61
  v_cvt_pk_bf16_f32 v87, v62, v63
  v_mfma_f32_32x32x16_bf16 v[48:63], v[128:131], v[32:35], 0
  buffer_load_dwordx4 v[196:199], v3, s[20:23], s80 offen offset:1024
  v_exp_f32 v64, v64
  v_exp_f32 v65, v65
  v_exp_f32 v66, v66
  v_exp_f32 v67, v67
  v_cvt_pk_bf16_f32 v88, v64, v65
  v_cvt_pk_bf16_f32 v89, v66, v67
  v_mfma_f32_32x32x16_bf16 v[48:63], v[132:135], v[36:39], v[48:63]
  v_exp_f32 v68, v68
  v_exp_f32 v69, v69
  v_exp_f32 v70, v70
  v_exp_f32 v71, v71
  s_waitcnt vmcnt(21)
  v_cvt_pk_bf16_f32 v90, v68, v69
  v_cvt_pk_bf16_f32 v91, v70, v71
  v_mfma_f32_32x32x16_bf16 a[0:15], v[136:139], v[80:83], a[0:15]
  buffer_load_dwordx4 v[120:123], v15, s[20:23], s36 offen offset:2048 sc1
  buffer_load_dwordx4 v[124:127], v15, s[20:23], s36 offen offset:3072 sc1
  v_exp_f32 v72, v72
  v_exp_f32 v73, v73
  v_exp_f32 v74, v74
  v_exp_f32 v75, v75
  v_cvt_pk_bf16_f32 v92, v72, v73
  v_cvt_pk_bf16_f32 v93, v74, v75
  v_mfma_f32_32x32x16_bf16 a[0:15], v[140:143], v[84:87], a[0:15]
  v_exp_f32 v76, v76
  v_exp_f32 v77, v77
  v_exp_f32 v78, v78
  v_exp_f32 v79, v79
  v_cvt_pk_bf16_f32 v94, v76, v77
  v_cvt_pk_bf16_f32 v95, v78, v79
  v_mfma_f32_32x32x16_bf16 v[64:79], v[128:131], v[40:43], 0
  buffer_load_dwordx4 v[200:203], v3, s[20:23], s80 offen offset:2048
  v_exp_f32 v48, v48
  v_exp_f32 v49, v49
  v_exp_f32 v50, v50
  v_exp_f32 v51, v51
  v_cvt_pk_bf16_f32 v80, v48, v49
  v_cvt_pk_bf16_f32 v81, v50, v51
  v_mfma_f32_32x32x16_bf16 v[64:79], v[132:135], v[44:47], v[64:79]
  v_exp_f32 v52, v52
  v_exp_f32 v53, v53
  v_exp_f32 v54, v54
  v_exp_f32 v55, v55
  v_cvt_pk_bf16_f32 v82, v52, v53
  v_cvt_pk_bf16_f32 v83, v54, v55
  v_mfma_f32_32x32x16_bf16 a[16:31], v[136:139], v[88:91], a[16:31]
  buffer_load_dwordx4 v[204:207], v3, s[20:23], s80 offen offset:3072
  v_exp_f32 v56, v56
  v_exp_f32 v57, v57
  v_exp_f32 v58, v58
  v_exp_f32 v59, v59
  v_cvt_pk_bf16_f32 v84, v56, v57
  v_cvt_pk_bf16_f32 v85, v58, v59
  v_mfma_f32_32x32x16_bf16 a[16:31], v[140:143], v[92:95], a[16:31]
  v_exp_f32 v60, v60
  v_exp_f32 v61, v61
  v_exp_f32 v62, v62
  v_exp_f32 v63, v63
  s_waitcnt vmcnt(23)
  v_cvt_pk_bf16_f32 v86, v60, v61
  v_cvt_pk_bf16_f32 v87, v62, v63
  v_mfma_f32_32x32x16_bf16 v[48:63], v[144:147], v[16:19], 0
  s_add_u32 s36, s36, 0x4000
  s_and_b32 s36, s36, 0x3ffff
  buffer_load_dwordx4 v[128:131], v15, s[20:23], s36 offen sc1
  buffer_load_dwordx4 v[132:135], v15, s[20:23], s36 offen offset:1024 sc1
  v_exp_f32 v64, v64
  v_exp_f32 v65, v65
  v_exp_f32 v66, v66
  v_exp_f32 v67, v67
  v_cvt_pk_bf16_f32 v88, v64, v65
  v_cvt_pk_bf16_f32 v89, v66, v67
  v_mfma_f32_32x32x16_bf16 v[48:63], v[148:151], v[20:23], v[48:63]
  s_add_u32 s80, s74, 12288
  buffer_load_dwordx4 v[208:211], v3, s[20:23], s80 offen offset:0
  v_exp_f32 v68, v68
  v_exp_f32 v69, v69
  v_exp_f32 v70, v70
  v_exp_f32 v71, v71
  v_cvt_pk_bf16_f32 v90, v68, v69
  v_cvt_pk_bf16_f32 v91, v70, v71
  v_mfma_f32_32x32x16_bf16 a[32:47], v[136:139], v[80:83], a[32:47]
  v_exp_f32 v72, v72
  v_exp_f32 v73, v73
  v_exp_f32 v74, v74
  v_exp_f32 v75, v75
  v_cvt_pk_bf16_f32 v92, v72, v73
  v_cvt_pk_bf16_f32 v93, v74, v75
  v_mfma_f32_32x32x16_bf16 a[32:47], v[140:143], v[84:87], a[32:47]
  buffer_load_dwordx4 v[212:215], v3, s[20:23], s80 offen offset:1024
  v_exp_f32 v76, v76
  v_exp_f32 v77, v77
  v_exp_f32 v78, v78
  v_exp_f32 v79, v79
  v_cvt_pk_bf16_f32 v94, v76, v77
  v_cvt_pk_bf16_f32 v95, v78, v79
  v_mfma_f32_32x32x16_bf16 v[64:79], v[144:147], v[24:27], 0
  v_exp_f32 v48, v48
  v_exp_f32 v49, v49
  v_exp_f32 v50, v50
  v_exp_f32 v51, v51
  v_cvt_pk_bf16_f32 v80, v48, v49
  v_cvt_pk_bf16_f32 v81, v50, v51
  v_mfma_f32_32x32x16_bf16 v[64:79], v[148:151], v[28:31], v[64:79]
  buffer_load_dwordx4 v[216:219], v3, s[20:23], s80 offen offset:2048
  v_exp_f32 v52, v52
  v_exp_f32 v53, v53
  v_exp_f32 v54, v54
  v_exp_f32 v55, v55
  v_cvt_pk_bf16_f32 v82, v52, v53
  v_cvt_pk_bf16_f32 v83, v54, v55
  v_mfma_f32_32x32x16_bf16 a[48:63], v[136:139], v[88:91], a[48:63]
  v_exp_f32 v56, v56
  v_exp_f32 v57, v57
  v_exp_f32 v58, v58
  v_exp_f32 v59, v59
  v_cvt_pk_bf16_f32 v84, v56, v57
  v_cvt_pk_bf16_f32 v85, v58, v59
  v_mfma_f32_32x32x16_bf16 a[48:63], v[140:143], v[92:95], a[48:63]
  buffer_load_dwordx4 v[220:223], v3, s[20:23], s80 offen offset:3072
  v_exp_f32 v60, v60
  v_exp_f32 v61, v61
  v_exp_f32 v62, v62
  v_exp_f32 v63, v63
  v_cvt_pk_bf16_f32 v86, v60, v61
  v_cvt_pk_bf16_f32 v87, v62, v63
  v_mfma_f32_32x32x16_bf16 v[48:63], v[144:147], v[32:35], 0
  s_add_u32 s80, s75, 0
  buffer_load_dwordx4 a[64:67], v3, s[20:23], s80 offen offset:0
  v_exp_f32 v64, v64
  v_exp_f32 v65, v65
  v_exp_f32 v66, v66
  v_exp_f32 v67, v67
  v_cvt_pk_bf16_f32 v88, v64, v65
  v_cvt_pk_bf16_f32 v89, v66, v67
  v_mfma_f32_32x32x16_bf16 v[48:63], v[148:151], v[36:39], v[48:63]
  v_exp_f32 v68, v68
  v_exp_f32 v69, v69
  v_exp_f32 v70, v70
  v_exp_f32 v71, v71
  s_waitcnt vmcnt(28)
  v_cvt_pk_bf16_f32 v90, v68, v69
  v_cvt_pk_bf16_f32 v91, v70, v71
  v_mfma_f32_32x32x16_bf16 a[0:15], v[152:155], v[80:83], a[0:15]
  buffer_load_dwordx4 v[136:139], v15, s[20:23], s36 offen offset:2048 sc1
  buffer_load_dwordx4 v[140:143], v15, s[20:23], s36 offen offset:3072 sc1
  v_exp_f32 v72, v72
  v_exp_f32 v73, v73
  v_exp_f32 v74, v74
  v_exp_f32 v75, v75
  v_cvt_pk_bf16_f32 v92, v72, v73
  v_cvt_pk_bf16_f32 v93, v74, v75
  v_mfma_f32_32x32x16_bf16 a[0:15], v[156:159], v[84:87], a[0:15]
  v_exp_f32 v76, v76
  v_exp_f32 v77, v77
  v_exp_f32 v78, v78
  v_exp_f32 v79, v79
  v_cvt_pk_bf16_f32 v94, v76, v77
  v_cvt_pk_bf16_f32 v95, v78, v79
  v_mfma_f32_32x32x16_bf16 v[64:79], v[144:147], v[40:43], 0
  buffer_load_dwordx4 a[68:71], v3, s[20:23], s80 offen offset:1024
  v_exp_f32 v48, v48
  v_exp_f32 v49, v49
  v_exp_f32 v50, v50
  v_exp_f32 v51, v51
  v_cvt_pk_bf16_f32 v80, v48, v49
  v_cvt_pk_bf16_f32 v81, v50, v51
  v_mfma_f32_32x32x16_bf16 v[64:79], v[148:151], v[44:47], v[64:79]
  v_exp_f32 v52, v52
  v_exp_f32 v53, v53
  v_exp_f32 v54, v54
  v_exp_f32 v55, v55
  v_cvt_pk_bf16_f32 v82, v52, v53
  v_cvt_pk_bf16_f32 v83, v54, v55
  v_mfma_f32_32x32x16_bf16 a[16:31], v[152:155], v[88:91], a[16:31]
  buffer_load_dwordx4 a[72:75], v3, s[20:23], s80 offen offset:2048
  v_exp_f32 v56, v56
  v_exp_f32 v57, v57
  v_exp_f32 v58, v58
  v_exp_f32 v59, v59
  v_cvt_pk_bf16_f32 v84, v56, v57
  v_cvt_pk_bf16_f32 v85, v58, v59
  v_mfma_f32_32x32x16_bf16 a[16:31], v[156:159], v[92:95], a[16:31]
  v_exp_f32 v60, v60
  v_exp_f32 v61, v61
  v_exp_f32 v62, v62
  v_exp_f32 v63, v63
  s_waitcnt vmcnt(29)
  v_cvt_pk_bf16_f32 v86, v60, v61
  v_cvt_pk_bf16_f32 v87, v62, v63
  v_mfma_f32_32x32x16_bf16 v[48:63], v[96:99], v[16:19], 0
  s_add_u32 s36, s36, 0x4000
  s_and_b32 s36, s36, 0x3ffff
  buffer_load_dwordx4 v[144:147], v15, s[20:23], s36 offen sc1
  buffer_load_dwordx4 v[148:151], v15, s[20:23], s36 offen offset:1024 sc1
  v_exp_f32 v64, v64
  v_exp_f32 v65, v65
  v_exp_f32 v66, v66
  v_exp_f32 v67, v67
  v_cvt_pk_bf16_f32 v88, v64, v65
  v_cvt_pk_bf16_f32 v89, v66, v67
  v_mfma_f32_32x32x16_bf16 v[48:63], v[100:103], v[20:23], v[48:63]
  buffer_load_dwordx4 a[76:79], v3, s[20:23], s80 offen offset:3072
  v_exp_f32 v68, v68
  v_exp_f32 v69, v69
  v_exp_f32 v70, v70
  v_exp_f32 v71, v71
  v_cvt_pk_bf16_f32 v90, v68, v69
  v_cvt_pk_bf16_f32 v91, v70, v71
  v_mfma_f32_32x32x16_bf16 a[32:47], v[152:155], v[80:83], a[32:47]
  v_exp_f32 v72, v72
  v_exp_f32 v73, v73
  v_exp_f32 v74, v74
  v_exp_f32 v75, v75
  v_cvt_pk_bf16_f32 v92, v72, v73
  v_cvt_pk_bf16_f32 v93, v74, v75
  v_mfma_f32_32x32x16_bf16 a[32:47], v[156:159], v[84:87], a[32:47]
  s_add_u32 s80, s75, 4096
  buffer_load_dwordx4 a[80:83], v3, s[20:23], s80 offen offset:0
  v_exp_f32 v76, v76
  v_exp_f32 v77, v77
  v_exp_f32 v78, v78
  v_exp_f32 v79, v79
  v_cvt_pk_bf16_f32 v94, v76, v77
  v_cvt_pk_bf16_f32 v95, v78, v79
  v_mfma_f32_32x32x16_bf16 v[64:79], v[96:99], v[24:27], 0
  v_exp_f32 v48, v48
  v_exp_f32 v49, v49
  v_exp_f32 v50, v50
  v_exp_f32 v51, v51
  v_cvt_pk_bf16_f32 v80, v48, v49
  v_cvt_pk_bf16_f32 v81, v50, v51
  v_mfma_f32_32x32x16_bf16 v[64:79], v[100:103], v[28:31], v[64:79]
  buffer_load_dwordx4 a[84:87], v3, s[20:23], s80 offen offset:1024
  v_exp_f32 v52, v52
  v_exp_f32 v53, v53
  v_exp_f32 v54, v54
  v_exp_f32 v55, v55
  v_cvt_pk_bf16_f32 v82, v52, v53
  v_cvt_pk_bf16_f32 v83, v54, v55
  v_mfma_f32_32x32x16_bf16 a[48:63], v[152:155], v[88:91], a[48:63]
  v_exp_f32 v56, v56
  v_exp_f32 v57, v57
  v_exp_f32 v58, v58
  v_exp_f32 v59, v59
  v_cvt_pk_bf16_f32 v84, v56, v57
  v_cvt_pk_bf16_f32 v85, v58, v59
  v_mfma_f32_32x32x16_bf16 a[48:63], v[156:159], v[92:95], a[48:63]
  buffer_load_dwordx4 a[88:91], v3, s[20:23], s80 offen offset:2048
  v_exp_f32 v60, v60
  v_exp_f32 v61, v61
  v_exp_f32 v62, v62
  v_exp_f32 v63, v63
  v_cvt_pk_bf16_f32 v86, v60, v61
  v_cvt_pk_bf16_f32 v87, v62, v63
  v_mfma_f32_32x32x16_bf16 v[48:63], v[96:99], v[32:35], 0
  buffer_load_dwordx4 a[92:95], v3, s[20:23], s80 offen offset:3072
  v_exp_f32 v64, v64
  v_exp_f32 v65, v65
  v_exp_f32 v66, v66
  v_exp_f32 v67, v67
  v_cvt_pk_bf16_f32 v88, v64, v65
  v_cvt_pk_bf16_f32 v89, v66, v67
  v_mfma_f32_32x32x16_bf16 v[48:63], v[100:103], v[36:39], v[48:63]
  v_exp_f32 v68, v68
  v_exp_f32 v69, v69
  v_exp_f32 v70, v70
  v_exp_f32 v71, v71
  s_waitcnt vmcnt(31)
  v_cvt_pk_bf16_f32 v90, v68, v69
  v_cvt_pk_bf16_f32 v91, v70, v71
  v_mfma_f32_32x32x16_bf16 a[0:15], v[104:107], v[80:83], a[0:15]
  buffer_load_dwordx4 v[152:155], v15, s[20:23], s36 offen offset:2048 sc1
  buffer_load_dwordx4 v[156:159], v15, s[20:23], s36 offen offset:3072 sc1
  v_exp_f32 v72, v72
  v_exp_f32 v73, v73
  v_exp_f32 v74, v74
  v_exp_f32 v75, v75
  v_cvt_pk_bf16_f32 v92, v72, v73
  v_cvt_pk_bf16_f32 v93, v74, v75
  v_mfma_f32_32x32x16_bf16 a[0:15], v[108:111], v[84:87], a[0:15]
  v_exp_f32 v76, v76
  v_exp_f32 v77, v77
  v_exp_f32 v78, v78
  v_exp_f32 v79, v79
  v_cvt_pk_bf16_f32 v94, v76, v77
  v_cvt_pk_bf16_f32 v95, v78, v79
  v_mfma_f32_32x32x16_bf16 v[64:79], v[96:99], v[40:43], 0
  s_add_u32 s80, s75, 8192
  buffer_load_dwordx4 a[96:99], v3, s[20:23], s80 offen offset:0
  v_exp_f32 v48, v48
  v_exp_f32 v49, v49
  v_exp_f32 v50, v50
  v_exp_f32 v51, v51
  v_cvt_pk_bf16_f32 v80, v48, v49
  v_cvt_pk_bf16_f32 v81, v50, v51
  v_mfma_f32_32x32x16_bf16 v[64:79], v[100:103], v[44:47], v[64:79]
  v_exp_f32 v52, v52
  v_exp_f32 v53, v53
  v_exp_f32 v54, v54
  v_exp_f32 v55, v55
  v_cvt_pk_bf16_f32 v82, v52, v53
  v_cvt_pk_bf16_f32 v83, v54, v55
  v_mfma_f32_32x32x16_bf16 a[16:31], v[104:107], v[88:91], a[16:31]
  buffer_load_dwordx4 a[100:103], v3, s[20:23], s80 offen offset:1024
  v_exp_f32 v56, v56
  v_exp_f32 v57, v57
  v_exp_f32 v58, v58
  v_exp_f32 v59, v59
  v_cvt_pk_bf16_f32 v84, v56, v57
  v_cvt_pk_bf16_f32 v85, v58, v59
  v_mfma_f32_32x32x16_bf16 a[16:31], v[108:111], v[92:95], a[16:31]
  v_exp_f32 v60, v60
  v_exp_f32 v61, v61
  v_exp_f32 v62, v62
  v_exp_f32 v63, v63
  s_waitcnt vmcnt(31)
  v_cvt_pk_bf16_f32 v86, v60, v61
  v_cvt_pk_bf16_f32 v87, v62, v63
  v_mfma_f32_32x32x16_bf16 v[48:63], v[112:115], v[16:19], 0
  s_add_u32 s36, s36, 0x4000
  s_and_b32 s36, s36, 0x3ffff
  buffer_load_dwordx4 v[96:99], v15, s[20:23], s36 offen sc1
  buffer_load_dwordx4 v[100:103], v15, s[20:23], s36 offen offset:1024 sc1
  v_exp_f32 v64, v64
  v_exp_f32 v65, v65
  v_exp_f32 v66, v66
  v_exp_f32 v67, v67
  v_cvt_pk_bf16_f32 v88, v64, v65
  v_cvt_pk_bf16_f32 v89, v66, v67
  v_mfma_f32_32x32x16_bf16 v[48:63], v[116:119], v[20:23], v[48:63]
  buffer_load_dwordx4 a[104:107], v3, s[20:23], s80 offen offset:2048
  v_exp_f32 v68, v68
  v_exp_f32 v69, v69
  v_exp_f32 v70, v70
  v_exp_f32 v71, v71
  v_cvt_pk_bf16_f32 v90, v68, v69
  v_cvt_pk_bf16_f32 v91, v70, v71
  v_mfma_f32_32x32x16_bf16 a[32:47], v[104:107], v[80:83], a[32:47]
  v_exp_f32 v72, v72
  v_exp_f32 v73, v73
  v_exp_f32 v74, v74
  v_exp_f32 v75, v75
  v_cvt_pk_bf16_f32 v92, v72, v73
  v_cvt_pk_bf16_f32 v93, v74, v75
  v_mfma_f32_32x32x16_bf16 a[32:47], v[108:111], v[84:87], a[32:47]
  buffer_load_dwordx4 a[108:111], v3, s[20:23], s80 offen offset:3072
  v_exp_f32 v76, v76
  v_exp_f32 v77, v77
  v_exp_f32 v78, v78
  v_exp_f32 v79, v79
  v_cvt_pk_bf16_f32 v94, v76, v77
  v_cvt_pk_bf16_f32 v95, v78, v79
  v_mfma_f32_32x32x16_bf16 v[64:79], v[112:115], v[24:27], 0
  v_exp_f32 v48, v48
  v_exp_f32 v49, v49
  v_exp_f32 v50, v50
  v_exp_f32 v51, v51
  v_cvt_pk_bf16_f32 v80, v48, v49
  v_cvt_pk_bf16_f32 v81, v50, v51
  v_mfma_f32_32x32x16_bf16 v[64:79], v[116:119], v[28:31], v[64:79]
  s_add_u32 s80, s75, 12288
  buffer_load_dwordx4 a[112:115], v3, s[20:23], s80 offen offset:0
  v_exp_f32 v52, v52
  v_exp_f32 v53, v53
  v_exp_f32 v54, v54
  v_exp_f32 v55, v55
  v_cvt_pk_bf16_f32 v82, v52, v53
  v_cvt_pk_bf16_f32 v83, v54, v55
  v_mfma_f32_32x32x16_bf16 a[48:63], v[104:107], v[88:91], a[48:63]
  v_exp_f32 v56, v56
  v_exp_f32 v57, v57
  v_exp_f32 v58, v58
  v_exp_f32 v59, v59
  v_cvt_pk_bf16_f32 v84, v56, v57
  v_cvt_pk_bf16_f32 v85, v58, v59
  v_mfma_f32_32x32x16_bf16 a[48:63], v[108:111], v[92:95], a[48:63]
  buffer_load_dwordx4 a[116:119], v3, s[20:23], s80 offen offset:1024
  v_exp_f32 v60, v60
  v_exp_f32 v61, v61
  v_exp_f32 v62, v62
  v_exp_f32 v63, v63
  v_cvt_pk_bf16_f32 v86, v60, v61
  v_cvt_pk_bf16_f32 v87, v62, v63
  v_mfma_f32_32x32x16_bf16 v[48:63], v[112:115], v[32:35], 0
  buffer_load_dwordx4 a[120:123], v3, s[20:23], s80 offen offset:2048
  v_exp_f32 v64, v64
  v_exp_f32 v65, v65
  v_exp_f32 v66, v66
  v_exp_f32 v67, v67
  v_cvt_pk_bf16_f32 v88, v64, v65
  v_cvt_pk_bf16_f32 v89, v66, v67
  v_mfma_f32_32x32x16_bf16 v[48:63], v[116:119], v[36:39], v[48:63]
  v_exp_f32 v68, v68
  v_exp_f32 v69, v69
  v_exp_f32 v70, v70
  v_exp_f32 v71, v71
  s_waitcnt vmcnt(31)
  v_cvt_pk_bf16_f32 v90, v68, v69
  v_cvt_pk_bf16_f32 v91, v70, v71
  v_mfma_f32_32x32x16_bf16 a[0:15], v[120:123], v[80:83], a[0:15]
  buffer_load_dwordx4 v[104:107], v15, s[20:23], s36 offen offset:2048 sc1
  buffer_load_dwordx4 v[108:111], v15, s[20:23], s36 offen offset:3072 sc1
  v_exp_f32 v72, v72
  v_exp_f32 v73, v73
  v_exp_f32 v74, v74
  v_exp_f32 v75, v75
  v_cvt_pk_bf16_f32 v92, v72, v73
  v_cvt_pk_bf16_f32 v93, v74, v75
  v_mfma_f32_32x32x16_bf16 a[0:15], v[124:127], v[84:87], a[0:15]
  v_exp_f32 v76, v76
  v_exp_f32 v77, v77
  v_exp_f32 v78, v78
  v_exp_f32 v79, v79
  v_cvt_pk_bf16_f32 v94, v76, v77
  v_cvt_pk_bf16_f32 v95, v78, v79
  v_mfma_f32_32x32x16_bf16 v[64:79], v[112:115], v[40:43], 0
  buffer_load_dwordx4 a[124:127], v3, s[20:23], s80 offen offset:3072
  v_exp_f32 v48, v48
  v_exp_f32 v49, v49
  v_exp_f32 v50, v50
  v_exp_f32 v51, v51
  v_cvt_pk_bf16_f32 v80, v48, v49
  v_cvt_pk_bf16_f32 v81, v50, v51
  v_mfma_f32_32x32x16_bf16 v[64:79], v[116:119], v[44:47], v[64:79]
  v_exp_f32 v52, v52
  v_exp_f32 v53, v53
  v_exp_f32 v54, v54
  v_exp_f32 v55, v55
  v_cvt_pk_bf16_f32 v82, v52, v53
  v_cvt_pk_bf16_f32 v83, v54, v55
  v_mfma_f32_32x32x16_bf16 a[16:31], v[120:123], v[88:91], a[16:31]
  buffer_load_dwordx4 a[128:131], v10, s[16:19], s53 offen offset:0
  v_exp_f32 v56, v56
  v_exp_f32 v57, v57
  v_exp_f32 v58, v58
  v_exp_f32 v59, v59
  v_cvt_pk_bf16_f32 v84, v56, v57
  v_cvt_pk_bf16_f32 v85, v58, v59
  v_mfma_f32_32x32x16_bf16 a[16:31], v[124:127], v[92:95], a[16:31]
  v_exp_f32 v60, v60
  v_exp_f32 v61, v61
  v_exp_f32 v62, v62
  v_exp_f32 v63, v63
  s_waitcnt vmcnt(31)
  v_cvt_pk_bf16_f32 v86, v60, v61
  v_cvt_pk_bf16_f32 v87, v62, v63
  v_mfma_f32_32x32x16_bf16 v[48:63], v[128:131], v[16:19], 0
  buffer_load_dwordx4 v[252:255], v8, s[20:23], s87 offen sc1
  s_add_u32 s36, s36, 0x4000
  s_and_b32 s36, s36, 0x3ffff
  buffer_load_dwordx4 v[112:115], v15, s[20:23], s36 offen sc1
  buffer_load_dwordx4 v[116:119], v15, s[20:23], s36 offen offset:1024 sc1
  v_exp_f32 v64, v64
  v_exp_f32 v65, v65
  v_exp_f32 v66, v66
  v_exp_f32 v67, v67
  v_cvt_pk_bf16_f32 v88, v64, v65
  v_cvt_pk_bf16_f32 v89, v66, v67
  v_mfma_f32_32x32x16_bf16 v[48:63], v[132:135], v[20:23], v[48:63]
  buffer_load_dwordx4 a[132:135], v10, s[16:19], s53 offen offset:16
  v_exp_f32 v68, v68
  v_exp_f32 v69, v69
  v_exp_f32 v70, v70
  v_exp_f32 v71, v71
  v_cvt_pk_bf16_f32 v90, v68, v69
  v_cvt_pk_bf16_f32 v91, v70, v71
  v_mfma_f32_32x32x16_bf16 a[32:47], v[120:123], v[80:83], a[32:47]
  v_exp_f32 v72, v72
  v_exp_f32 v73, v73
  v_exp_f32 v74, v74
  v_exp_f32 v75, v75
  v_cvt_pk_bf16_f32 v92, v72, v73
  v_cvt_pk_bf16_f32 v93, v74, v75
  v_mfma_f32_32x32x16_bf16 a[32:47], v[124:127], v[84:87], a[32:47]
  buffer_load_dwordx4 a[136:139], v11, s[20:23], s54 offen offset:0
  v_exp_f32 v76, v76
  v_exp_f32 v77, v77
  v_exp_f32 v78, v78
  v_exp_f32 v79, v79
  v_cvt_pk_bf16_f32 v94, v76, v77
  v_cvt_pk_bf16_f32 v95, v78, v79
  v_mfma_f32_32x32x16_bf16 v[64:79], v[128:131], v[24:27], 0
  v_exp_f32 v48, v48
  v_exp_f32 v49, v49
  v_exp_f32 v50, v50
  v_exp_f32 v51, v51
  v_cvt_pk_bf16_f32 v80, v48, v49
  v_cvt_pk_bf16_f32 v81, v50, v51
  v_mfma_f32_32x32x16_bf16 v[64:79], v[132:135], v[28:31], v[64:79]
  buffer_load_dwordx4 a[140:143], v11, s[20:23], s54 offen offset:32
  v_exp_f32 v52, v52
  v_exp_f32 v53, v53
  v_exp_f32 v54, v54
  v_exp_f32 v55, v55
  v_cvt_pk_bf16_f32 v82, v52, v53
  v_cvt_pk_bf16_f32 v83, v54, v55
  v_mfma_f32_32x32x16_bf16 a[48:63], v[120:123], v[88:91], a[48:63]
  v_exp_f32 v56, v56
  v_exp_f32 v57, v57
  v_exp_f32 v58, v58
  v_exp_f32 v59, v59
  v_cvt_pk_bf16_f32 v84, v56, v57
  v_cvt_pk_bf16_f32 v85, v58, v59
  v_mfma_f32_32x32x16_bf16 a[48:63], v[124:127], v[92:95], a[48:63]
  buffer_load_dwordx4 a[144:147], v11, s[20:23], s54 offen offset:64
  v_exp_f32 v60, v60
  v_exp_f32 v61, v61
  v_exp_f32 v62, v62
  v_exp_f32 v63, v63
  v_cvt_pk_bf16_f32 v86, v60, v61
  v_cvt_pk_bf16_f32 v87, v62, v63
  v_mfma_f32_32x32x16_bf16 v[48:63], v[128:131], v[32:35], 0
  buffer_load_dwordx4 a[148:151], v11, s[20:23], s54 offen offset:96
  v_exp_f32 v64, v64
  v_exp_f32 v65, v65
  v_exp_f32 v66, v66
  v_exp_f32 v67, v67
  v_cvt_pk_bf16_f32 v88, v64, v65
  v_cvt_pk_bf16_f32 v89, v66, v67
  v_mfma_f32_32x32x16_bf16 v[48:63], v[132:135], v[36:39], v[48:63]
  v_exp_f32 v68, v68
  v_exp_f32 v69, v69
  v_exp_f32 v70, v70
  v_exp_f32 v71, v71
  s_waitcnt vmcnt(32)
  v_cvt_pk_bf16_f32 v90, v68, v69
  v_cvt_pk_bf16_f32 v91, v70, v71
  v_mfma_f32_32x32x16_bf16 a[0:15], v[136:139], v[80:83], a[0:15]
  buffer_load_dwordx4 v[120:123], v15, s[20:23], s36 offen offset:2048 sc1
  buffer_load_dwordx4 v[124:127], v15, s[20:23], s36 offen offset:3072 sc1
  v_exp_f32 v72, v72
  v_exp_f32 v73, v73
  v_exp_f32 v74, v74
  v_exp_f32 v75, v75
  v_cvt_pk_bf16_f32 v92, v72, v73
  v_cvt_pk_bf16_f32 v93, v74, v75
  v_mfma_f32_32x32x16_bf16 a[0:15], v[140:143], v[84:87], a[0:15]
  v_exp_f32 v76, v76
  v_exp_f32 v77, v77
  v_exp_f32 v78, v78
  v_exp_f32 v79, v79
  v_cvt_pk_bf16_f32 v94, v76, v77
  v_cvt_pk_bf16_f32 v95, v78, v79
  v_mfma_f32_32x32x16_bf16 v[64:79], v[128:131], v[40:43], 0
  s_add_u32 s80, s76, 16384
  buffer_load_dwordx4 a[160:163], v3, s[20:23], s80 offen offset:0
  v_exp_f32 v48, v48
  v_exp_f32 v49, v49
  v_exp_f32 v50, v50
  v_exp_f32 v51, v51
  v_cvt_pk_bf16_f32 v80, v48, v49
  v_cvt_pk_bf16_f32 v81, v50, v51
  v_mfma_f32_32x32x16_bf16 v[64:79], v[132:135], v[44:47], v[64:79]
  v_exp_f32 v52, v52
  v_exp_f32 v53, v53
  v_exp_f32 v54, v54
  v_exp_f32 v55, v55
  v_cvt_pk_bf16_f32 v82, v52, v53
  v_cvt_pk_bf16_f32 v83, v54, v55
  v_mfma_f32_32x32x16_bf16 a[16:31], v[136:139], v[88:91], a[16:31]
  buffer_load_dwordx4 a[168:171], v3, s[20:23], s80 offen offset:1024
  v_exp_f32 v56, v56
  v_exp_f32 v57, v57
  v_exp_f32 v58, v58
  v_exp_f32 v59, v59
  v_cvt_pk_bf16_f32 v84, v56, v57
  v_cvt_pk_bf16_f32 v85, v58, v59
  v_mfma_f32_32x32x16_bf16 a[16:31], v[140:143], v[92:95], a[16:31]
  v_exp_f32 v60, v60
  v_exp_f32 v61, v61
  v_exp_f32 v62, v62
  v_exp_f32 v63, v63
  s_waitcnt vmcnt(32)
  v_cvt_pk_bf16_f32 v86, v60, v61
  v_cvt_pk_bf16_f32 v87, v62, v63
  v_mfma_f32_32x32x16_bf16 v[48:63], v[144:147], v[16:19], 0
  s_add_u32 s36, s36, 0x4000
  s_and_b32 s36, s36, 0x3ffff
  buffer_load_dwordx4 v[128:131], v15, s[20:23], s36 offen sc1
  buffer_load_dwordx4 v[132:135], v15, s[20:23], s36 offen offset:1024 sc1
  v_exp_f32 v64, v64
  v_exp_f32 v65, v65
  v_exp_f32 v66, v66
  v_exp_f32 v67, v67
  v_cvt_pk_bf16_f32 v88, v64, v65
  v_cvt_pk_bf16_f32 v89, v66, v67
  v_mfma_f32_32x32x16_bf16 v[48:63], v[148:151], v[20:23], v[48:63]
  buffer_load_dwordx4 a[176:179], v3, s[20:23], s80 offen offset:2048
  v_exp_f32 v68, v68
  v_exp_f32 v69, v69
  v_exp_f32 v70, v70
  v_exp_f32 v71, v71
  v_cvt_pk_bf16_f32 v90, v68, v69
  v_cvt_pk_bf16_f32 v91, v70, v71
  v_mfma_f32_32x32x16_bf16 a[32:47], v[136:139], v[80:83], a[32:47]
  v_exp_f32 v72, v72
  v_exp_f32 v73, v73
  v_exp_f32 v74, v74
  v_exp_f32 v75, v75
  v_cvt_pk_bf16_f32 v92, v72, v73
  v_cvt_pk_bf16_f32 v93, v74, v75
  v_mfma_f32_32x32x16_bf16 a[32:47], v[140:143], v[84:87], a[32:47]
  buffer_load_dwordx4 a[184:187], v3, s[20:23], s80 offen offset:3072
  v_exp_f32 v76, v76
  v_exp_f32 v77, v77
  v_exp_f32 v78, v78
  v_exp_f32 v79, v79
  v_cvt_pk_bf16_f32 v94, v76, v77
  v_cvt_pk_bf16_f32 v95, v78, v79
  v_mfma_f32_32x32x16_bf16 v[64:79], v[144:147], v[24:27], 0
  v_exp_f32 v48, v48
  v_exp_f32 v49, v49
  v_exp_f32 v50, v50
  v_exp_f32 v51, v51
  v_cvt_pk_bf16_f32 v80, v48, v49
  v_cvt_pk_bf16_f32 v81, v50, v51
  v_mfma_f32_32x32x16_bf16 v[64:79], v[148:151], v[28:31], v[64:79]
  s_add_u32 s80, s77, 16384
  buffer_load_dwordx4 a[164:167], v3, s[20:23], s80 offen offset:0
  v_exp_f32 v52, v52
  v_exp_f32 v53, v53
  v_exp_f32 v54, v54
  v_exp_f32 v55, v55
  v_cvt_pk_bf16_f32 v82, v52, v53
  v_cvt_pk_bf16_f32 v83, v54, v55
  v_mfma_f32_32x32x16_bf16 a[48:63], v[136:139], v[88:91], a[48:63]
  v_exp_f32 v56, v56
  v_exp_f32 v57, v57
  v_exp_f32 v58, v58
  v_exp_f32 v59, v59
  v_cvt_pk_bf16_f32 v84, v56, v57
  v_cvt_pk_bf16_f32 v85, v58, v59
  v_mfma_f32_32x32x16_bf16 a[48:63], v[140:143], v[92:95], a[48:63]
  buffer_load_dwordx4 a[172:175], v3, s[20:23], s80 offen offset:1024
  v_exp_f32 v60, v60
  v_exp_f32 v61, v61
  v_exp_f32 v62, v62
  v_exp_f32 v63, v63
  v_cvt_pk_bf16_f32 v86, v60, v61
  v_cvt_pk_bf16_f32 v87, v62, v63
  v_mfma_f32_32x32x16_bf16 v[48:63], v[144:147], v[32:35], 0
  buffer_load_dwordx4 a[180:183], v3, s[20:23], s80 offen offset:2048
  v_exp_f32 v64, v64
  v_exp_f32 v65, v65
  v_exp_f32 v66, v66
  v_exp_f32 v67, v67
  v_cvt_pk_bf16_f32 v88, v64, v65
  v_cvt_pk_bf16_f32 v89, v66, v67
  v_mfma_f32_32x32x16_bf16 v[48:63], v[148:151], v[36:39], v[48:63]
  v_exp_f32 v68, v68
  v_exp_f32 v69, v69
  v_exp_f32 v70, v70
  v_exp_f32 v71, v71
  s_waitcnt vmcnt(32)
  v_cvt_pk_bf16_f32 v90, v68, v69
  v_cvt_pk_bf16_f32 v91, v70, v71
  v_mfma_f32_32x32x16_bf16 a[0:15], v[152:155], v[80:83], a[0:15]
  buffer_load_dwordx4 v[136:139], v15, s[20:23], s36 offen offset:2048 sc1
  buffer_load_dwordx4 v[140:143], v15, s[20:23], s36 offen offset:3072 sc1
  v_exp_f32 v72, v72
  v_exp_f32 v73, v73
  v_exp_f32 v74, v74
  v_exp_f32 v75, v75
  v_cvt_pk_bf16_f32 v92, v72, v73
  v_cvt_pk_bf16_f32 v93, v74, v75
  v_mfma_f32_32x32x16_bf16 a[0:15], v[156:159], v[84:87], a[0:15]
  v_exp_f32 v76, v76
  v_exp_f32 v77, v77
  v_exp_f32 v78, v78
  v_exp_f32 v79, v79
  v_cvt_pk_bf16_f32 v94, v76, v77
  v_cvt_pk_bf16_f32 v95, v78, v79
  v_mfma_f32_32x32x16_bf16 v[64:79], v[144:147], v[40:43], 0
  buffer_load_dwordx4 a[188:191], v3, s[20:23], s80 offen offset:3072
  v_exp_f32 v48, v48
  v_exp_f32 v49, v49
  v_exp_f32 v50, v50
  v_exp_f32 v51, v51
  v_cvt_pk_bf16_f32 v80, v48, v49
  v_cvt_pk_bf16_f32 v81, v50, v51
  v_mfma_f32_32x32x16_bf16 v[64:79], v[148:151], v[44:47], v[64:79]
  v_exp_f32 v52, v52
  v_exp_f32 v53, v53
  v_exp_f32 v54, v54
  v_exp_f32 v55, v55
  v_cvt_pk_bf16_f32 v82, v52, v53
  v_cvt_pk_bf16_f32 v83, v54, v55
  v_mfma_f32_32x32x16_bf16 a[16:31], v[152:155], v[88:91], a[16:31]
  s_add_u32 s80, s76, 20480
  buffer_load_dwordx4 a[192:195], v3, s[20:23], s80 offen offset:0
  v_exp_f32 v56, v56
  v_exp_f32 v57, v57
  v_exp_f32 v58, v58
  v_exp_f32 v59, v59
  v_cvt_pk_bf16_f32 v84, v56, v57
  v_cvt_pk_bf16_f32 v85, v58, v59
  v_mfma_f32_32x32x16_bf16 a[16:31], v[156:159], v[92:95], a[16:31]
  v_exp_f32 v60, v60
  v_exp_f32 v61, v61
  v_exp_f32 v62, v62
  v_exp_f32 v63, v63
  s_waitcnt vmcnt(32)
  v_cvt_pk_bf16_f32 v86, v60, v61
  v_cvt_pk_bf16_f32 v87, v62, v63
  v_mfma_f32_32x32x16_bf16 v[48:63], v[96:99], v[16:19], 0
  s_add_u32 s36, s36, 0x4000
  s_and_b32 s36, s36, 0x3ffff
  buffer_load_dwordx4 v[144:147], v15, s[20:23], s36 offen sc1
  buffer_load_dwordx4 v[148:151], v15, s[20:23], s36 offen offset:1024 sc1
  s_waitcnt vmcnt(24)
  v_xor_b32 v252, v9, v252
  v_xor_b32 v253, v9, v253
  v_xor_b32 v254, v9, v254
  v_xor_b32 v255, v9, v255
  v_or3_b32 v252, v252, v253, v254
  v_or_b32 v252, v252, v255
  v_cmp_ne_u32 vcc, 0, v252
  s_nop 0
  s_cmp_eq_u64 vcc, 0
  s_cselect_b32 s62, s57, 1073741824
  s_cselect_b32 s71, s59, 1073741824
  v_exp_f32 v64, v64
  v_exp_f32 v65, v65
  v_exp_f32 v66, v66
  v_exp_f32 v67, v67
  v_cvt_pk_bf16_f32 v88, v64, v65
  v_cvt_pk_bf16_f32 v89, v66, v67
  v_mfma_f32_32x32x16_bf16 v[48:63], v[100:103], v[20:23], v[48:63]
  buffer_load_dwordx4 a[200:203], v3, s[20:23], s80 offen offset:1024
  v_exp_f32 v68, v68
  v_exp_f32 v69, v69
  v_exp_f32 v70, v70
  v_exp_f32 v71, v71
  v_cvt_pk_bf16_f32 v90, v68, v69
  v_cvt_pk_bf16_f32 v91, v70, v71
  v_mfma_f32_32x32x16_bf16 a[32:47], v[152:155], v[80:83], a[32:47]
  v_exp_f32 v72, v72
  v_exp_f32 v73, v73
  v_exp_f32 v74, v74
  v_exp_f32 v75, v75
  v_cvt_pk_bf16_f32 v92, v72, v73
  v_cvt_pk_bf16_f32 v93, v74, v75
  v_mfma_f32_32x32x16_bf16 a[32:47], v[156:159], v[84:87], a[32:47]
  buffer_load_dwordx4 a[208:211], v3, s[20:23], s80 offen offset:2048
  v_exp_f32 v76, v76
  v_exp_f32 v77, v77
  v_exp_f32 v78, v78
  v_exp_f32 v79, v79
  v_cvt_pk_bf16_f32 v94, v76, v77
  v_cvt_pk_bf16_f32 v95, v78, v79
  v_mfma_f32_32x32x16_bf16 v[64:79], v[96:99], v[24:27], 0
  v_exp_f32 v48, v48
  v_exp_f32 v49, v49
  v_exp_f32 v50, v50
  v_exp_f32 v51, v51
  v_cvt_pk_bf16_f32 v80, v48, v49
  v_cvt_pk_bf16_f32 v81, v50, v51
  v_mfma_f32_32x32x16_bf16 v[64:79], v[100:103], v[28:31], v[64:79]
  buffer_load_dwordx2 v[224:225], v14, s[20:23], s71 offen sc1
  s_add_u32 s71, s71, 28672
  v_exp_f32 v52, v52
  v_exp_f32 v53, v53
  v_exp_f32 v54, v54
  v_exp_f32 v55, v55
  v_cvt_pk_bf16_f32 v82, v52, v53
  v_cvt_pk_bf16_f32 v83, v54, v55
  v_mfma_f32_32x32x16_bf16 a[48:63], v[152:155], v[88:91], a[48:63]
  v_exp_f32 v56, v56
  v_exp_f32 v57, v57
  v_exp_f32 v58, v58
  v_exp_f32 v59, v59
  v_cvt_pk_bf16_f32 v84, v56, v57
  v_cvt_pk_bf16_f32 v85, v58, v59
  v_mfma_f32_32x32x16_bf16 a[48:63], v[156:159], v[92:95], a[48:63]
  buffer_load_dwordx2 v[226:227], v14, s[20:23], s71 offen sc1
  s_add_u32 s71, s71, 28672
  v_exp_f32 v60, v60
  v_exp_f32 v61, v61
  v_exp_f32 v62, v62
  v_exp_f32 v63, v63
  v_cvt_pk_bf16_f32 v86, v60, v61
  v_cvt_pk_bf16_f32 v87, v62, v63
  v_mfma_f32_32x32x16_bf16 v[48:63], v[96:99], v[32:35], 0
  buffer_load_dwordx4 a[216:219], v3, s[20:23], s80 offen offset:3072
  v_exp_f32 v64, v64
  v_exp_f32 v65, v65
  v_exp_f32 v66, v66
  v_exp_f32 v67, v67
  v_cvt_pk_bf16_f32 v88, v64, v65
  v_cvt_pk_bf16_f32 v89, v66, v67
  v_mfma_f32_32x32x16_bf16 v[48:63], v[100:103], v[36:39], v[48:63]
  v_exp_f32 v68, v68
  v_exp_f32 v69, v69
  v_exp_f32 v70, v70
  v_exp_f32 v71, v71
  s_waitcnt vmcnt(32)
  v_cvt_pk_bf16_f32 v90, v68, v69
  v_cvt_pk_bf16_f32 v91, v70, v71
  v_mfma_f32_32x32x16_bf16 a[0:15], v[104:107], v[80:83], a[0:15]
  buffer_load_dwordx4 v[152:155], v15, s[20:23], s36 offen offset:2048 sc1
  buffer_load_dwordx4 v[156:159], v15, s[20:23], s36 offen offset:3072 sc1
  v_exp_f32 v72, v72
  v_exp_f32 v73, v73
  v_exp_f32 v74, v74
  v_exp_f32 v75, v75
  v_cvt_pk_bf16_f32 v92, v72, v73
  v_cvt_pk_bf16_f32 v93, v74, v75
  v_mfma_f32_32x32x16_bf16 a[0:15], v[108:111], v[84:87], a[0:15]
  v_exp_f32 v76, v76
  v_exp_f32 v77, v77
  v_exp_f32 v78, v78
  v_exp_f32 v79, v79
  v_cvt_pk_bf16_f32 v94, v76, v77
  v_cvt_pk_bf16_f32 v95, v78, v79
  v_mfma_f32_32x32x16_bf16 v[64:79], v[96:99], v[40:43], 0
  buffer_load_dwordx2 v[228:229], v14, s[20:23], s71 offen sc1
  s_add_u32 s71, s71, 28672
  v_exp_f32 v48, v48
  v_exp_f32 v49, v49
  v_exp_f32 v50, v50
  v_exp_f32 v51, v51
  v_cvt_pk_bf16_f32 v80, v48, v49
  v_cvt_pk_bf16_f32 v81, v50, v51
  v_mfma_f32_32x32x16_bf16 v[64:79], v[100:103], v[44:47], v[64:79]
  v_exp_f32 v52, v52
  v_exp_f32 v53, v53
  v_exp_f32 v54, v54
  v_exp_f32 v55, v55
  v_cvt_pk_bf16_f32 v82, v52, v53
  v_cvt_pk_bf16_f32 v83, v54, v55
  v_mfma_f32_32x32x16_bf16 a[16:31], v[104:107], v[88:91], a[16:31]
  buffer_load_dwordx2 v[230:231], v14, s[20:23], s71 offen sc1
  s_add_u32 s71, s71, 28672
  v_exp_f32 v56, v56
  v_exp_f32 v57, v57
  v_exp_f32 v58, v58
  v_exp_f32 v59, v59
  v_cvt_pk_bf16_f32 v84, v56, v57
  v_cvt_pk_bf16_f32 v85, v58, v59
  v_mfma_f32_32x32x16_bf16 a[16:31], v[108:111], v[92:95], a[16:31]
  v_exp_f32 v60, v60
  v_exp_f32 v61, v61
  v_exp_f32 v62, v62
  v_exp_f32 v63, v63
  s_waitcnt vmcnt(31)
  v_cvt_pk_bf16_f32 v86, v60, v61
  v_cvt_pk_bf16_f32 v87, v62, v63
  v_mfma_f32_32x32x16_bf16 v[48:63], v[112:115], v[16:19], 0
  s_add_u32 s36, s36, 0x4000
  s_and_b32 s36, s36, 0x3ffff
  buffer_load_dwordx4 v[96:99], v15, s[20:23], s36 offen sc1
  buffer_load_dwordx4 v[100:103], v15, s[20:23], s36 offen offset:1024 sc1
  v_exp_f32 v64, v64
  v_exp_f32 v65, v65
  v_exp_f32 v66, v66
  v_exp_f32 v67, v67
  v_cvt_pk_bf16_f32 v88, v64, v65
  v_cvt_pk_bf16_f32 v89, v66, v67
  v_mfma_f32_32x32x16_bf16 v[48:63], v[116:119], v[20:23], v[48:63]
  s_add_u32 s80, s77, 20480
  buffer_load_dwordx4 a[196:199], v3, s[20:23], s80 offen offset:0
  v_exp_f32 v68, v68
  v_exp_f32 v69, v69
  v_exp_f32 v70, v70
  v_exp_f32 v71, v71
  v_cvt_pk_bf16_f32 v90, v68, v69
  v_cvt_pk_bf16_f32 v91, v70, v71
  v_mfma_f32_32x32x16_bf16 a[32:47], v[104:107], v[80:83], a[32:47]
  v_exp_f32 v72, v72
  v_exp_f32 v73, v73
  v_exp_f32 v74, v74
  v_exp_f32 v75, v75
  v_cvt_pk_bf16_f32 v92, v72, v73
  v_cvt_pk_bf16_f32 v93, v74, v75
  v_mfma_f32_32x32x16_bf16 a[32:47], v[108:111], v[84:87], a[32:47]
  buffer_load_dwordx4 a[204:207], v3, s[20:23], s80 offen offset:1024
  v_exp_f32 v76, v76
  v_exp_f32 v77, v77
  v_exp_f32 v78, v78
  v_exp_f32 v79, v79
  v_cvt_pk_bf16_f32 v94, v76, v77
  v_cvt_pk_bf16_f32 v95, v78, v79
  v_mfma_f32_32x32x16_bf16 v[64:79], v[112:115], v[24:27], 0
  v_exp_f32 v48, v48
  v_exp_f32 v49, v49
  v_exp_f32 v50, v50
  v_exp_f32 v51, v51
  v_cvt_pk_bf16_f32 v80, v48, v49
  v_cvt_pk_bf16_f32 v81, v50, v51
  v_mfma_f32_32x32x16_bf16 v[64:79], v[116:119], v[28:31], v[64:79]
  buffer_load_dwordx2 v[232:233], v14, s[20:23], s71 offen sc1
  s_add_u32 s71, s71, 28672
  v_exp_f32 v52, v52
  v_exp_f32 v53, v53
  v_exp_f32 v54, v54
  v_exp_f32 v55, v55
  v_cvt_pk_bf16_f32 v82, v52, v53
  v_cvt_pk_bf16_f32 v83, v54, v55
  v_mfma_f32_32x32x16_bf16 a[48:63], v[104:107], v[88:91], a[48:63]
  v_exp_f32 v56, v56
  v_exp_f32 v57, v57
  v_exp_f32 v58, v58
  v_exp_f32 v59, v59
  v_cvt_pk_bf16_f32 v84, v56, v57
  v_cvt_pk_bf16_f32 v85, v58, v59
  v_mfma_f32_32x32x16_bf16 a[48:63], v[108:111], v[92:95], a[48:63]
  buffer_load_dwordx2 v[234:235], v14, s[20:23], s71 offen sc1
  s_add_u32 s71, s71, 28672
  v_exp_f32 v60, v60
  v_exp_f32 v61, v61
  v_exp_f32 v62, v62
  v_exp_f32 v63, v63
  v_cvt_pk_bf16_f32 v86, v60, v61
  v_cvt_pk_bf16_f32 v87, v62, v63
  v_mfma_f32_32x32x16_bf16 v[48:63], v[112:115], v[32:35], 0
  buffer_load_dwordx4 a[212:215], v3, s[20:23], s80 offen offset:2048
  v_exp_f32 v64, v64
  v_exp_f32 v65, v65
  v_exp_f32 v66, v66
  v_exp_f32 v67, v67
  v_cvt_pk_bf16_f32 v88, v64, v65
  v_cvt_pk_bf16_f32 v89, v66, v67
  v_mfma_f32_32x32x16_bf16 v[48:63], v[116:119], v[36:39], v[48:63]
  v_exp_f32 v68, v68
  v_exp_f32 v69, v69
  v_exp_f32 v70, v70
  v_exp_f32 v71, v71
  s_waitcnt vmcnt(31)
  v_cvt_pk_bf16_f32 v90, v68, v69
  v_cvt_pk_bf16_f32 v91, v70, v71
  v_mfma_f32_32x32x16_bf16 a[0:15], v[120:123], v[80:83], a[0:15]
  buffer_load_dwordx4 v[104:107], v15, s[20:23], s36 offen offset:2048 sc1
  buffer_load_dwordx4 v[108:111], v15, s[20:23], s36 offen offset:3072 sc1
  v_exp_f32 v72, v72
  v_exp_f32 v73, v73
  v_exp_f32 v74, v74
  v_exp_f32 v75, v75
  v_cvt_pk_bf16_f32 v92, v72, v73
  v_cvt_pk_bf16_f32 v93, v74, v75
  v_mfma_f32_32x32x16_bf16 a[0:15], v[124:127], v[84:87], a[0:15]
  v_exp_f32 v76, v76
  v_exp_f32 v77, v77
  v_exp_f32 v78, v78
  v_exp_f32 v79, v79
  v_cvt_pk_bf16_f32 v94, v76, v77
  v_cvt_pk_bf16_f32 v95, v78, v79
  v_mfma_f32_32x32x16_bf16 v[64:79], v[112:115], v[40:43], 0
  buffer_load_dwordx2 v[236:237], v14, s[20:23], s71 offen sc1
  s_add_u32 s71, s71, 28672
  v_exp_f32 v48, v48
  v_exp_f32 v49, v49
  v_exp_f32 v50, v50
  v_exp_f32 v51, v51
  v_cvt_pk_bf16_f32 v80, v48, v49
  v_cvt_pk_bf16_f32 v81, v50, v51
  v_mfma_f32_32x32x16_bf16 v[64:79], v[116:119], v[44:47], v[64:79]
  v_exp_f32 v52, v52
  v_exp_f32 v53, v53
  v_exp_f32 v54, v54
  v_exp_f32 v55, v55
  v_cvt_pk_bf16_f32 v82, v52, v53
  v_cvt_pk_bf16_f32 v83, v54, v55
  v_mfma_f32_32x32x16_bf16 a[16:31], v[120:123], v[88:91], a[16:31]
  buffer_load_dwordx2 v[238:239], v14, s[20:23], s71 offen sc1
  s_add_u32 s71, s71, 28672
  v_exp_f32 v56, v56
  v_exp_f32 v57, v57
  v_exp_f32 v58, v58
  v_exp_f32 v59, v59
  v_cvt_pk_bf16_f32 v84, v56, v57
  v_cvt_pk_bf16_f32 v85, v58, v59
  v_mfma_f32_32x32x16_bf16 a[16:31], v[124:127], v[92:95], a[16:31]
  v_exp_f32 v60, v60
  v_exp_f32 v61, v61
  v_exp_f32 v62, v62
  v_exp_f32 v63, v63
  s_waitcnt vmcnt(31)
  v_cvt_pk_bf16_f32 v86, v60, v61
  v_cvt_pk_bf16_f32 v87, v62, v63
  v_mfma_f32_32x32x16_bf16 v[48:63], v[128:131], v[16:19], 0
  s_add_u32 s36, s39, 16384
  s_and_b32 s36, s36, 0xc000
  s_and_b32 s37, s39, 0x30000
  s_or_b32 s36, s36, s37
  buffer_load_dwordx4 v[112:115], v15, s[20:23], s36 offen sc1
  buffer_load_dwordx4 v[116:119], v15, s[20:23], s36 offen offset:1024 sc1
  v_exp_f32 v64, v64
  v_exp_f32 v65, v65
  v_exp_f32 v66, v66
  v_exp_f32 v67, v67
  v_cvt_pk_bf16_f32 v88, v64, v65
  v_cvt_pk_bf16_f32 v89, v66, v67
  v_mfma_f32_32x32x16_bf16 v[48:63], v[132:135], v[20:23], v[48:63]
  buffer_load_dwordx4 a[220:223], v3, s[20:23], s80 offen offset:3072
  v_exp_f32 v68, v68
  v_exp_f32 v69, v69
  v_exp_f32 v70, v70
  v_exp_f32 v71, v71
  v_cvt_pk_bf16_f32 v90, v68, v69
  v_cvt_pk_bf16_f32 v91, v70, v71
  v_mfma_f32_32x32x16_bf16 a[32:47], v[120:123], v[80:83], a[32:47]
  v_exp_f32 v72, v72
  v_exp_f32 v73, v73
  v_exp_f32 v74, v74
  v_exp_f32 v75, v75
  v_cvt_pk_bf16_f32 v92, v72, v73
  v_cvt_pk_bf16_f32 v93, v74, v75
  v_mfma_f32_32x32x16_bf16 a[32:47], v[124:127], v[84:87], a[32:47]
  s_add_u32 s80, s76, 24576
  buffer_load_dwordx4 a[224:227], v3, s[20:23], s80 offen offset:0
  v_exp_f32 v76, v76
  v_exp_f32 v77, v77
  v_exp_f32 v78, v78
  v_exp_f32 v79, v79
  v_cvt_pk_bf16_f32 v94, v76, v77
  v_cvt_pk_bf16_f32 v95, v78, v79
  v_mfma_f32_32x32x16_bf16 v[64:79], v[128:131], v[24:27], 0
  v_exp_f32 v48, v48
  v_exp_f32 v49, v49
  v_exp_f32 v50, v50
  v_exp_f32 v51, v51
  v_cvt_pk_bf16_f32 v80, v48, v49
  v_cvt_pk_bf16_f32 v81, v50, v51
  v_mfma_f32_32x32x16_bf16 v[64:79], v[132:135], v[28:31], v[64:79]
  buffer_load_dwordx2 v[240:241], v14, s[20:23], s71 offen sc1
  s_add_u32 s71, s71, 28672
  v_exp_f32 v52, v52
  v_exp_f32 v53, v53
  v_exp_f32 v54, v54
  v_exp_f32 v55, v55
  v_cvt_pk_bf16_f32 v82, v52, v53
  v_cvt_pk_bf16_f32 v83, v54, v55
  v_mfma_f32_32x32x16_bf16 a[48:63], v[120:123], v[88:91], a[48:63]
  v_exp_f32 v56, v56
  v_exp_f32 v57, v57
  v_exp_f32 v58, v58
  v_exp_f32 v59, v59
  v_cvt_pk_bf16_f32 v84, v56, v57
  v_cvt_pk_bf16_f32 v85, v58, v59
  v_mfma_f32_32x32x16_bf16 a[48:63], v[124:127], v[92:95], a[48:63]
  buffer_load_dwordx2 v[242:243], v14, s[20:23], s71 offen sc1
  s_add_u32 s71, s71, 28672
  v_exp_f32 v60, v60
  v_exp_f32 v61, v61
  v_exp_f32 v62, v62
  v_exp_f32 v63, v63
  v_cvt_pk_bf16_f32 v86, v60, v61
  v_cvt_pk_bf16_f32 v87, v62, v63
  v_mfma_f32_32x32x16_bf16 v[48:63], v[128:131], v[32:35], 0
  buffer_load_dwordx4 a[232:235], v3, s[20:23], s80 offen offset:1024
  v_exp_f32 v64, v64
  v_exp_f32 v65, v65
  v_exp_f32 v66, v66
  v_exp_f32 v67, v67
  v_cvt_pk_bf16_f32 v88, v64, v65
  v_cvt_pk_bf16_f32 v89, v66, v67
  v_mfma_f32_32x32x16_bf16 v[48:63], v[132:135], v[36:39], v[48:63]
  v_exp_f32 v68, v68
  v_exp_f32 v69, v69
  v_exp_f32 v70, v70
  v_exp_f32 v71, v71
  s_waitcnt vmcnt(31)
  v_cvt_pk_bf16_f32 v90, v68, v69
  v_cvt_pk_bf16_f32 v91, v70, v71
  v_mfma_f32_32x32x16_bf16 a[0:15], v[136:139], v[80:83], a[0:15]
  buffer_load_dwordx4 v[120:123], v15, s[20:23], s36 offen offset:2048 sc1
  buffer_load_dwordx4 v[124:127], v15, s[20:23], s36 offen offset:3072 sc1
  v_exp_f32 v72, v72
  v_exp_f32 v73, v73
  v_exp_f32 v74, v74
  v_exp_f32 v75, v75
  v_cvt_pk_bf16_f32 v92, v72, v73
  v_cvt_pk_bf16_f32 v93, v74, v75
  v_mfma_f32_32x32x16_bf16 a[0:15], v[140:143], v[84:87], a[0:15]
  v_exp_f32 v76, v76
  v_exp_f32 v77, v77
  v_exp_f32 v78, v78
  v_exp_f32 v79, v79
  v_cvt_pk_bf16_f32 v94, v76, v77
  v_cvt_pk_bf16_f32 v95, v78, v79
  v_mfma_f32_32x32x16_bf16 v[64:79], v[128:131], v[40:43], 0
  buffer_load_dwordx2 v[244:245], v14, s[20:23], s71 offen sc1
  s_add_u32 s71, s71, 28672
  v_exp_f32 v48, v48
  v_exp_f32 v49, v49
  v_exp_f32 v50, v50
  v_exp_f32 v51, v51
  v_cvt_pk_bf16_f32 v80, v48, v49
  v_cvt_pk_bf16_f32 v81, v50, v51
  v_mfma_f32_32x32x16_bf16 v[64:79], v[132:135], v[44:47], v[64:79]
  v_exp_f32 v52, v52
  v_exp_f32 v53, v53
  v_exp_f32 v54, v54
  v_exp_f32 v55, v55
  v_cvt_pk_bf16_f32 v82, v52, v53
  v_cvt_pk_bf16_f32 v83, v54, v55
  v_mfma_f32_32x32x16_bf16 a[16:31], v[136:139], v[88:91], a[16:31]
  buffer_load_dwordx2 v[246:247], v14, s[20:23], s71 offen sc1
  s_add_u32 s71, s71, 28672
  v_exp_f32 v56, v56
  v_exp_f32 v57, v57
  v_exp_f32 v58, v58
  v_exp_f32 v59, v59
  v_cvt_pk_bf16_f32 v84, v56, v57
  v_cvt_pk_bf16_f32 v85, v58, v59
  v_mfma_f32_32x32x16_bf16 a[16:31], v[140:143], v[92:95], a[16:31]
  v_exp_f32 v60, v60
  v_exp_f32 v61, v61
  v_exp_f32 v62, v62
  v_exp_f32 v63, v63
  s_waitcnt vmcnt(31)
  v_cvt_pk_bf16_f32 v86, v60, v61
  v_cvt_pk_bf16_f32 v87, v62, v63
  v_mfma_f32_32x32x16_bf16 v[48:63], v[144:147], v[16:19], 0
  s_add_u32 s36, s39, 32768
  s_and_b32 s36, s36, 0xc000
  s_and_b32 s37, s39, 0x30000
  s_or_b32 s36, s36, s37
  buffer_load_dwordx4 v[128:131], v15, s[20:23], s36 offen sc1
  buffer_load_dwordx4 v[132:135], v15, s[20:23], s36 offen offset:1024 sc1
  v_exp_f32 v64, v64
  v_exp_f32 v65, v65
  v_exp_f32 v66, v66
  v_exp_f32 v67, v67
  v_cvt_pk_bf16_f32 v88, v64, v65
  v_cvt_pk_bf16_f32 v89, v66, v67
  v_mfma_f32_32x32x16_bf16 v[48:63], v[148:151], v[20:23], v[48:63]
  buffer_load_dwordx4 a[240:243], v3, s[20:23], s80 offen offset:2048
  v_exp_f32 v68, v68
  v_exp_f32 v69, v69
  v_exp_f32 v70, v70
  v_exp_f32 v71, v71
  v_cvt_pk_bf16_f32 v90, v68, v69
  v_cvt_pk_bf16_f32 v91, v70, v71
  v_mfma_f32_32x32x16_bf16 a[32:47], v[136:139], v[80:83], a[32:47]
  v_exp_f32 v72, v72
  v_exp_f32 v73, v73
  v_exp_f32 v74, v74
  v_exp_f32 v75, v75
  v_cvt_pk_bf16_f32 v92, v72, v73
  v_cvt_pk_bf16_f32 v93, v74, v75
  v_mfma_f32_32x32x16_bf16 a[32:47], v[140:143], v[84:87], a[32:47]
  buffer_load_dwordx4 a[248:251], v3, s[20:23], s80 offen offset:3072
  v_exp_f32 v76, v76
  v_exp_f32 v77, v77
  v_exp_f32 v78, v78
  v_exp_f32 v79, v79
  v_cvt_pk_bf16_f32 v94, v76, v77
  v_cvt_pk_bf16_f32 v95, v78, v79
  v_mfma_f32_32x32x16_bf16 v[64:79], v[144:147], v[24:27], 0
  v_exp_f32 v48, v48
  v_exp_f32 v49, v49
  v_exp_f32 v50, v50
  v_exp_f32 v51, v51
  v_cvt_pk_bf16_f32 v80, v48, v49
  v_cvt_pk_bf16_f32 v81, v50, v51
  v_mfma_f32_32x32x16_bf16 v[64:79], v[148:151], v[28:31], v[64:79]
  buffer_load_dwordx2 v[248:249], v14, s[20:23], s71 offen sc1
  s_add_u32 s71, s71, 28672
  v_exp_f32 v52, v52
  v_exp_f32 v53, v53
  v_exp_f32 v54, v54
  v_exp_f32 v55, v55
  v_cvt_pk_bf16_f32 v82, v52, v53
  v_cvt_pk_bf16_f32 v83, v54, v55
  v_mfma_f32_32x32x16_bf16 a[48:63], v[136:139], v[88:91], a[48:63]
  v_exp_f32 v56, v56
  v_exp_f32 v57, v57
  v_exp_f32 v58, v58
  v_exp_f32 v59, v59
  v_cvt_pk_bf16_f32 v84, v56, v57
  v_cvt_pk_bf16_f32 v85, v58, v59
  v_mfma_f32_32x32x16_bf16 a[48:63], v[140:143], v[92:95], a[48:63]
  buffer_load_dwordx2 v[250:251], v14, s[20:23], s71 offen sc1
  v_exp_f32 v60, v60
  v_exp_f32 v61, v61
  v_exp_f32 v62, v62
  v_exp_f32 v63, v63
  v_cvt_pk_bf16_f32 v86, v60, v61
  v_cvt_pk_bf16_f32 v87, v62, v63
  v_mfma_f32_32x32x16_bf16 v[48:63], v[144:147], v[32:35], 0
  s_add_u32 s80, s77, 24576
  buffer_load_dwordx4 a[228:231], v3, s[20:23], s80 offen offset:0
  v_exp_f32 v64, v64
  v_exp_f32 v65, v65
  v_exp_f32 v66, v66
  v_exp_f32 v67, v67
  v_cvt_pk_bf16_f32 v88, v64, v65
  v_cvt_pk_bf16_f32 v89, v66, v67
  v_mfma_f32_32x32x16_bf16 v[48:63], v[148:151], v[36:39], v[48:63]
  v_exp_f32 v68, v68
  v_exp_f32 v69, v69
  v_exp_f32 v70, v70
  v_exp_f32 v71, v71
  s_waitcnt vmcnt(31)
  v_cvt_pk_bf16_f32 v90, v68, v69
  v_cvt_pk_bf16_f32 v91, v70, v71
  v_mfma_f32_32x32x16_bf16 a[0:15], v[152:155], v[80:83], a[0:15]
  buffer_load_dwordx4 v[136:139], v15, s[20:23], s36 offen offset:2048 sc1
  buffer_load_dwordx4 v[140:143], v15, s[20:23], s36 offen offset:3072 sc1
  v_exp_f32 v72, v72
  v_exp_f32 v73, v73
  v_exp_f32 v74, v74
  v_exp_f32 v75, v75
  v_cvt_pk_bf16_f32 v92, v72, v73
  v_cvt_pk_bf16_f32 v93, v74, v75
  v_mfma_f32_32x32x16_bf16 a[0:15], v[156:159], v[84:87], a[0:15]
  v_exp_f32 v76, v76
  v_exp_f32 v77, v77
  v_exp_f32 v78, v78
  v_exp_f32 v79, v79
  v_cvt_pk_bf16_f32 v94, v76, v77
  v_cvt_pk_bf16_f32 v95, v78, v79
  v_mfma_f32_32x32x16_bf16 v[64:79], v[144:147], v[40:43], 0
  s_add_u32 s64, s58, 0
  s_mov_b32 m0, s64
  s_add_u32 s65, s62, 0
  buffer_load_dwordx4 v3, s[20:23], s65 offen offset:0 sc1 lds
  v_exp_f32 v48, v48
  v_exp_f32 v49, v49
  v_exp_f32 v50, v50
  v_exp_f32 v51, v51
  v_cvt_pk_bf16_f32 v80, v48, v49
  v_cvt_pk_bf16_f32 v81, v50, v51
  v_mfma_f32_32x32x16_bf16 v[64:79], v[148:151], v[44:47], v[64:79]
  v_exp_f32 v52, v52
  v_exp_f32 v53, v53
  v_exp_f32 v54, v54
  v_exp_f32 v55, v55
  v_cvt_pk_bf16_f32 v82, v52, v53
  v_cvt_pk_bf16_f32 v83, v54, v55
  v_mfma_f32_32x32x16_bf16 a[16:31], v[152:155], v[88:91], a[16:31]
  buffer_load_dwordx4 v3, s[20:23], s65 offen offset:1024 sc1 lds
  v_exp_f32 v56, v56
  v_exp_f32 v57, v57
  v_exp_f32 v58, v58
  v_exp_f32 v59, v59
  v_cvt_pk_bf16_f32 v84, v56, v57
  v_cvt_pk_bf16_f32 v85, v58, v59
  v_mfma_f32_32x32x16_bf16 a[16:31], v[156:159], v[92:95], a[16:31]
  v_exp_f32 v60, v60
  v_exp_f32 v61, v61
  v_exp_f32 v62, v62
  v_exp_f32 v63, v63
  s_waitcnt vmcnt(31)
  v_cvt_pk_bf16_f32 v86, v60, v61
  v_cvt_pk_bf16_f32 v87, v62, v63
  v_mfma_f32_32x32x16_bf16 v[48:63], v[96:99], v[16:19], 0
  s_add_u32 s36, s39, 49152
  s_and_b32 s36, s36, 0xc000
  s_and_b32 s37, s39, 0x30000
  s_or_b32 s36, s36, s37
  buffer_load_dwordx4 v[144:147], v15, s[20:23], s36 offen sc1
  buffer_load_dwordx4 v[148:151], v15, s[20:23], s36 offen offset:1024 sc1
  v_exp_f32 v64, v64
  v_exp_f32 v65, v65
  v_exp_f32 v66, v66
  v_exp_f32 v67, v67
  v_cvt_pk_bf16_f32 v88, v64, v65
  v_cvt_pk_bf16_f32 v89, v66, v67
  v_mfma_f32_32x32x16_bf16 v[48:63], v[100:103], v[20:23], v[48:63]
  buffer_load_dwordx4 a[236:239], v3, s[20:23], s80 offen offset:1024
  v_exp_f32 v68, v68
  v_exp_f32 v69, v69
  v_exp_f32 v70, v70
  v_exp_f32 v71, v71
  v_cvt_pk_bf16_f32 v90, v68, v69
  v_cvt_pk_bf16_f32 v91, v70, v71
  v_mfma_f32_32x32x16_bf16 a[32:47], v[152:155], v[80:83], a[32:47]
  v_exp_f32 v72, v72
  v_exp_f32 v73, v73
  v_exp_f32 v74, v74
  v_exp_f32 v75, v75
  v_cvt_pk_bf16_f32 v92, v72, v73
  v_cvt_pk_bf16_f32 v93, v74, v75
  v_mfma_f32_32x32x16_bf16 a[32:47], v[156:159], v[84:87], a[32:47]
  buffer_load_dwordx4 a[244:247], v3, s[20:23], s80 offen offset:2048
  v_exp_f32 v76, v76
  v_exp_f32 v77, v77
  v_exp_f32 v78, v78
  v_exp_f32 v79, v79
  v_cvt_pk_bf16_f32 v94, v76, v77
  v_cvt_pk_bf16_f32 v95, v78, v79
  v_mfma_f32_32x32x16_bf16 v[64:79], v[96:99], v[24:27], 0
  v_exp_f32 v48, v48
  v_exp_f32 v49, v49
  v_exp_f32 v50, v50
  v_exp_f32 v51, v51
  v_cvt_pk_bf16_f32 v80, v48, v49
  v_cvt_pk_bf16_f32 v81, v50, v51
  v_mfma_f32_32x32x16_bf16 v[64:79], v[100:103], v[28:31], v[64:79]
  buffer_load_dwordx4 v3, s[20:23], s65 offen offset:2048 sc1 lds
  v_exp_f32 v52, v52
  v_exp_f32 v53, v53
  v_exp_f32 v54, v54
  v_exp_f32 v55, v55
  v_cvt_pk_bf16_f32 v82, v52, v53
  v_cvt_pk_bf16_f32 v83, v54, v55
  v_mfma_f32_32x32x16_bf16 a[48:63], v[152:155], v[88:91], a[48:63]
  v_exp_f32 v56, v56
  v_exp_f32 v57, v57
  v_exp_f32 v58, v58
  v_exp_f32 v59, v59
  v_cvt_pk_bf16_f32 v84, v56, v57
  v_cvt_pk_bf16_f32 v85, v58, v59
  v_mfma_f32_32x32x16_bf16 a[48:63], v[156:159], v[92:95], a[48:63]
  buffer_load_dwordx4 v3, s[20:23], s65 offen offset:3072 sc1 lds
  v_exp_f32 v60, v60
  v_exp_f32 v61, v61
  v_exp_f32 v62, v62
  v_exp_f32 v63, v63
  v_cvt_pk_bf16_f32 v86, v60, v61
  v_cvt_pk_bf16_f32 v87, v62, v63
  v_mfma_f32_32x32x16_bf16 v[48:63], v[96:99], v[32:35], 0
  buffer_load_dwordx4 a[252:255], v3, s[20:23], s80 offen offset:3072
  v_exp_f32 v64, v64
  v_exp_f32 v65, v65
  v_exp_f32 v66, v66
  v_exp_f32 v67, v67
  v_cvt_pk_bf16_f32 v88, v64, v65
  v_cvt_pk_bf16_f32 v89, v66, v67
  v_mfma_f32_32x32x16_bf16 v[48:63], v[100:103], v[36:39], v[48:63]
  v_exp_f32 v68, v68
  v_exp_f32 v69, v69
  v_exp_f32 v70, v70
  v_exp_f32 v71, v71
  s_waitcnt vmcnt(31)
  v_cvt_pk_bf16_f32 v90, v68, v69
  v_cvt_pk_bf16_f32 v91, v70, v71
  v_mfma_f32_32x32x16_bf16 a[0:15], v[104:107], v[80:83], a[0:15]
  buffer_load_dwordx4 v[152:155], v15, s[20:23], s36 offen offset:2048 sc1
  buffer_load_dwordx4 v[156:159], v15, s[20:23], s36 offen offset:3072 sc1
  v_exp_f32 v72, v72
  v_exp_f32 v73, v73
  v_exp_f32 v74, v74
  v_exp_f32 v75, v75
  v_cvt_pk_bf16_f32 v92, v72, v73
  v_cvt_pk_bf16_f32 v93, v74, v75
  v_mfma_f32_32x32x16_bf16 a[0:15], v[108:111], v[84:87], a[0:15]
  v_exp_f32 v76, v76
  v_exp_f32 v77, v77
  v_exp_f32 v78, v78
  v_exp_f32 v79, v79
  v_cvt_pk_bf16_f32 v94, v76, v77
  v_cvt_pk_bf16_f32 v95, v78, v79
  v_mfma_f32_32x32x16_bf16 v[64:79], v[96:99], v[40:43], 0
  s_add_u32 s64, s64, 4096
  s_mov_b32 m0, s64
  s_add_u32 s65, s65, 4096
  buffer_load_dwordx4 v3, s[20:23], s65 offen offset:0 sc1 lds
  v_exp_f32 v48, v48
  v_exp_f32 v49, v49
  v_exp_f32 v50, v50
  v_exp_f32 v51, v51
  v_cvt_pk_bf16_f32 v80, v48, v49
  v_cvt_pk_bf16_f32 v81, v50, v51
  v_mfma_f32_32x32x16_bf16 v[64:79], v[100:103], v[44:47], v[64:79]
  v_exp_f32 v52, v52
  v_exp_f32 v53, v53
  v_exp_f32 v54, v54
  v_exp_f32 v55, v55
  v_cvt_pk_bf16_f32 v82, v52, v53
  v_cvt_pk_bf16_f32 v83, v54, v55
  v_mfma_f32_32x32x16_bf16 a[16:31], v[104:107], v[88:91], a[16:31]
  buffer_load_dwordx4 v3, s[20:23], s65 offen offset:1024 sc1 lds
  v_exp_f32 v56, v56
  v_exp_f32 v57, v57
  v_exp_f32 v58, v58
  v_exp_f32 v59, v59
  v_cvt_pk_bf16_f32 v84, v56, v57
  v_cvt_pk_bf16_f32 v85, v58, v59
  v_mfma_f32_32x32x16_bf16 a[16:31], v[108:111], v[92:95], a[16:31]
  v_exp_f32 v60, v60
  v_exp_f32 v61, v61
  v_exp_f32 v62, v62
  v_exp_f32 v63, v63
  s_waitcnt vmcnt(31)
  v_cvt_pk_bf16_f32 v86, v60, v61
  v_cvt_pk_bf16_f32 v87, v62, v63
  v_mfma_f32_32x32x16_bf16 v[48:63], v[112:115], v[16:19], 0
  v_exp_f32 v64, v64
  v_exp_f32 v65, v65
  v_exp_f32 v66, v66
  v_exp_f32 v67, v67
  v_cvt_pk_bf16_f32 v88, v64, v65
  v_cvt_pk_bf16_f32 v89, v66, v67
  v_mfma_f32_32x32x16_bf16 v[48:63], v[116:119], v[20:23], v[48:63]
  buffer_load_dwordx4 v3, s[20:23], s65 offen offset:2048 sc1 lds
  v_exp_f32 v68, v68
  v_exp_f32 v69, v69
  v_exp_f32 v70, v70
  v_exp_f32 v71, v71
  v_cvt_pk_bf16_f32 v90, v68, v69
  v_cvt_pk_bf16_f32 v91, v70, v71
  v_mfma_f32_32x32x16_bf16 a[32:47], v[104:107], v[80:83], a[32:47]
  v_exp_f32 v72, v72
  v_exp_f32 v73, v73
  v_exp_f32 v74, v74
  v_exp_f32 v75, v75
  v_cvt_pk_bf16_f32 v92, v72, v73
  v_cvt_pk_bf16_f32 v93, v74, v75
  v_mfma_f32_32x32x16_bf16 a[32:47], v[108:111], v[84:87], a[32:47]
  s_add_u32 s64, s58, 28672
  s_mov_b32 m0, s64
  s_add_u32 s65, s62, 28672
  buffer_load_dwordx4 v3, s[20:23], s65 offen offset:0 sc1 lds
  v_exp_f32 v76, v76
  v_exp_f32 v77, v77
  v_exp_f32 v78, v78
  v_exp_f32 v79, v79
  v_cvt_pk_bf16_f32 v94, v76, v77
  v_cvt_pk_bf16_f32 v95, v78, v79
  v_mfma_f32_32x32x16_bf16 v[64:79], v[112:115], v[24:27], 0
  v_exp_f32 v48, v48
  v_exp_f32 v49, v49
  v_exp_f32 v50, v50
  v_exp_f32 v51, v51
  v_cvt_pk_bf16_f32 v80, v48, v49
  v_cvt_pk_bf16_f32 v81, v50, v51
  v_mfma_f32_32x32x16_bf16 v[64:79], v[116:119], v[28:31], v[64:79]
  buffer_load_dwordx4 v3, s[20:23], s65 offen offset:1024 sc1 lds
  v_exp_f32 v52, v52
  v_exp_f32 v53, v53
  v_exp_f32 v54, v54
  v_exp_f32 v55, v55
  v_cvt_pk_bf16_f32 v82, v52, v53
  v_cvt_pk_bf16_f32 v83, v54, v55
  v_mfma_f32_32x32x16_bf16 a[48:63], v[104:107], v[88:91], a[48:63]
  v_exp_f32 v56, v56
  v_exp_f32 v57, v57
  v_exp_f32 v58, v58
  v_exp_f32 v59, v59
  v_cvt_pk_bf16_f32 v84, v56, v57
  v_cvt_pk_bf16_f32 v85, v58, v59
  v_mfma_f32_32x32x16_bf16 a[48:63], v[108:111], v[92:95], a[48:63]
  buffer_load_dwordx4 v3, s[20:23], s65 offen offset:2048 sc1 lds
  v_exp_f32 v60, v60
  v_exp_f32 v61, v61
  v_exp_f32 v62, v62
  v_exp_f32 v63, v63
  v_cvt_pk_bf16_f32 v86, v60, v61
  v_cvt_pk_bf16_f32 v87, v62, v63
  v_mfma_f32_32x32x16_bf16 v[48:63], v[112:115], v[32:35], 0
  buffer_load_dwordx4 v3, s[20:23], s65 offen offset:3072 sc1 lds
  v_exp_f32 v64, v64
  v_exp_f32 v65, v65
  v_exp_f32 v66, v66
  v_exp_f32 v67, v67
  v_cvt_pk_bf16_f32 v88, v64, v65
  v_cvt_pk_bf16_f32 v89, v66, v67
  v_mfma_f32_32x32x16_bf16 v[48:63], v[116:119], v[36:39], v[48:63]
  v_exp_f32 v68, v68
  v_exp_f32 v69, v69
  v_exp_f32 v70, v70
  v_exp_f32 v71, v71
  s_waitcnt vmcnt(29)
  v_cvt_pk_bf16_f32 v90, v68, v69
  v_cvt_pk_bf16_f32 v91, v70, v71
  v_mfma_f32_32x32x16_bf16 a[0:15], v[120:123], v[80:83], a[0:15]
  v_exp_f32 v72, v72
  v_exp_f32 v73, v73
  v_exp_f32 v74, v74
  v_exp_f32 v75, v75
  v_cvt_pk_bf16_f32 v92, v72, v73
  v_cvt_pk_bf16_f32 v93, v74, v75
  v_mfma_f32_32x32x16_bf16 a[0:15], v[124:127], v[84:87], a[0:15]
  v_exp_f32 v76, v76
  v_exp_f32 v77, v77
  v_exp_f32 v78, v78
  v_exp_f32 v79, v79
  v_cvt_pk_bf16_f32 v94, v76, v77
  v_cvt_pk_bf16_f32 v95, v78, v79
  v_mfma_f32_32x32x16_bf16 v[64:79], v[112:115], v[40:43], 0
  s_add_u32 s64, s64, 4096
  s_mov_b32 m0, s64
  s_add_u32 s65, s65, 4096
  buffer_load_dwordx4 v3, s[20:23], s65 offen offset:0 sc1 lds
  v_exp_f32 v48, v48
  v_exp_f32 v49, v49
  v_exp_f32 v50, v50
  v_exp_f32 v51, v51
  v_cvt_pk_bf16_f32 v80, v48, v49
  v_cvt_pk_bf16_f32 v81, v50, v51
  v_mfma_f32_32x32x16_bf16 v[64:79], v[116:119], v[44:47], v[64:79]
  v_exp_f32 v52, v52
  v_exp_f32 v53, v53
  v_exp_f32 v54, v54
  v_exp_f32 v55, v55
  v_cvt_pk_bf16_f32 v82, v52, v53
  v_cvt_pk_bf16_f32 v83, v54, v55
  v_mfma_f32_32x32x16_bf16 a[16:31], v[120:123], v[88:91], a[16:31]
  buffer_load_dwordx4 v3, s[20:23], s65 offen offset:1024 sc1 lds
  v_exp_f32 v56, v56
  v_exp_f32 v57, v57
  v_exp_f32 v58, v58
  v_exp_f32 v59, v59
  v_cvt_pk_bf16_f32 v84, v56, v57
  v_cvt_pk_bf16_f32 v85, v58, v59
  v_mfma_f32_32x32x16_bf16 a[16:31], v[124:127], v[92:95], a[16:31]
  v_exp_f32 v60, v60
  v_exp_f32 v61, v61
  v_exp_f32 v62, v62
  v_exp_f32 v63, v63
  s_waitcnt vmcnt(27)
  v_cvt_pk_bf16_f32 v86, v60, v61
  v_cvt_pk_bf16_f32 v87, v62, v63
  v_mfma_f32_32x32x16_bf16 v[48:63], v[128:131], v[16:19], 0
  v_exp_f32 v64, v64
  v_exp_f32 v65, v65
  v_exp_f32 v66, v66
  v_exp_f32 v67, v67
  v_cvt_pk_bf16_f32 v88, v64, v65
  v_cvt_pk_bf16_f32 v89, v66, v67
  v_mfma_f32_32x32x16_bf16 v[48:63], v[132:135], v[20:23], v[48:63]
  buffer_load_dwordx4 v3, s[20:23], s65 offen offset:2048 sc1 lds
  v_exp_f32 v68, v68
  v_exp_f32 v69, v69
  v_exp_f32 v70, v70
  v_exp_f32 v71, v71
  v_cvt_pk_bf16_f32 v90, v68, v69
  v_cvt_pk_bf16_f32 v91, v70, v71
  v_mfma_f32_32x32x16_bf16 a[32:47], v[120:123], v[80:83], a[32:47]
  v_exp_f32 v72, v72
  v_exp_f32 v73, v73
  v_exp_f32 v74, v74
  v_exp_f32 v75, v75
  v_cvt_pk_bf16_f32 v92, v72, v73
  v_cvt_pk_bf16_f32 v93, v74, v75
  v_mfma_f32_32x32x16_bf16 a[32:47], v[124:127], v[84:87], a[32:47]
  s_add_u32 s64, s58, 57344
  s_mov_b32 m0, s64
  s_add_u32 s65, s62, 57344
  buffer_load_dwordx4 v3, s[20:23], s65 offen offset:0 sc1 lds
  v_exp_f32 v76, v76
  v_exp_f32 v77, v77
  v_exp_f32 v78, v78
  v_exp_f32 v79, v79
  v_cvt_pk_bf16_f32 v94, v76, v77
  v_cvt_pk_bf16_f32 v95, v78, v79
  v_mfma_f32_32x32x16_bf16 v[64:79], v[128:131], v[24:27], 0
  v_exp_f32 v48, v48
  v_exp_f32 v49, v49
  v_exp_f32 v50, v50
  v_exp_f32 v51, v51
  v_cvt_pk_bf16_f32 v80, v48, v49
  v_cvt_pk_bf16_f32 v81, v50, v51
  v_mfma_f32_32x32x16_bf16 v[64:79], v[132:135], v[28:31], v[64:79]
  buffer_load_dwordx4 v3, s[20:23], s65 offen offset:1024 sc1 lds
  v_exp_f32 v52, v52
  v_exp_f32 v53, v53
  v_exp_f32 v54, v54
  v_exp_f32 v55, v55
  v_cvt_pk_bf16_f32 v82, v52, v53
  v_cvt_pk_bf16_f32 v83, v54, v55
  v_mfma_f32_32x32x16_bf16 a[48:63], v[120:123], v[88:91], a[48:63]
  v_exp_f32 v56, v56
  v_exp_f32 v57, v57
  v_exp_f32 v58, v58
  v_exp_f32 v59, v59
  v_cvt_pk_bf16_f32 v84, v56, v57
  v_cvt_pk_bf16_f32 v85, v58, v59
  v_mfma_f32_32x32x16_bf16 a[48:63], v[124:127], v[92:95], a[48:63]
  buffer_load_dwordx4 v3, s[20:23], s65 offen offset:2048 sc1 lds
  v_exp_f32 v60, v60
  v_exp_f32 v61, v61
  v_exp_f32 v62, v62
  v_exp_f32 v63, v63
  v_cvt_pk_bf16_f32 v86, v60, v61
  v_cvt_pk_bf16_f32 v87, v62, v63
  v_mfma_f32_32x32x16_bf16 v[48:63], v[128:131], v[32:35], 0
  buffer_load_dwordx4 v3, s[20:23], s65 offen offset:3072 sc1 lds
  v_exp_f32 v64, v64
  v_exp_f32 v65, v65
  v_exp_f32 v66, v66
  v_exp_f32 v67, v67
  v_cvt_pk_bf16_f32 v88, v64, v65
  v_cvt_pk_bf16_f32 v89, v66, v67
  v_mfma_f32_32x32x16_bf16 v[48:63], v[132:135], v[36:39], v[48:63]
  v_exp_f32 v68, v68
  v_exp_f32 v69, v69
  v_exp_f32 v70, v70
  v_exp_f32 v71, v71
  s_waitcnt vmcnt(25)
  v_cvt_pk_bf16_f32 v90, v68, v69
  v_cvt_pk_bf16_f32 v91, v70, v71
  v_mfma_f32_32x32x16_bf16 a[0:15], v[136:139], v[80:83], a[0:15]
  v_exp_f32 v72, v72
  v_exp_f32 v73, v73
  v_exp_f32 v74, v74
  v_exp_f32 v75, v75
  v_cvt_pk_bf16_f32 v92, v72, v73
  v_cvt_pk_bf16_f32 v93, v74, v75
  v_mfma_f32_32x32x16_bf16 a[0:15], v[140:143], v[84:87], a[0:15]
  v_exp_f32 v76, v76
  v_exp_f32 v77, v77
  v_exp_f32 v78, v78
  v_exp_f32 v79, v79
  v_cvt_pk_bf16_f32 v94, v76, v77
  v_cvt_pk_bf16_f32 v95, v78, v79
  v_mfma_f32_32x32x16_bf16 v[64:79], v[128:131], v[40:43], 0
  s_add_u32 s64, s64, 4096
  s_mov_b32 m0, s64
  s_add_u32 s65, s65, 4096
  buffer_load_dwordx4 v3, s[20:23], s65 offen offset:0 sc1 lds
  v_exp_f32 v48, v48
  v_exp_f32 v49, v49
  v_exp_f32 v50, v50
  v_exp_f32 v51, v51
  v_cvt_pk_bf16_f32 v80, v48, v49
  v_cvt_pk_bf16_f32 v81, v50, v51
  v_mfma_f32_32x32x16_bf16 v[64:79], v[132:135], v[44:47], v[64:79]
  v_exp_f32 v52, v52
  v_exp_f32 v53, v53
  v_exp_f32 v54, v54
  v_exp_f32 v55, v55
  v_cvt_pk_bf16_f32 v82, v52, v53
  v_cvt_pk_bf16_f32 v83, v54, v55
  v_mfma_f32_32x32x16_bf16 a[16:31], v[136:139], v[88:91], a[16:31]
  buffer_load_dwordx4 v3, s[20:23], s65 offen offset:1024 sc1 lds
  v_exp_f32 v56, v56
  v_exp_f32 v57, v57
  v_exp_f32 v58, v58
  v_exp_f32 v59, v59
  v_cvt_pk_bf16_f32 v84, v56, v57
  v_cvt_pk_bf16_f32 v85, v58, v59
  v_mfma_f32_32x32x16_bf16 a[16:31], v[140:143], v[92:95], a[16:31]
  v_exp_f32 v60, v60
  v_exp_f32 v61, v61
  v_exp_f32 v62, v62
  v_exp_f32 v63, v63
  s_waitcnt vmcnt(23)
  v_cvt_pk_bf16_f32 v86, v60, v61
  v_cvt_pk_bf16_f32 v87, v62, v63
  v_mfma_f32_32x32x16_bf16 v[48:63], v[144:147], v[16:19], 0
  v_exp_f32 v64, v64
  v_exp_f32 v65, v65
  v_exp_f32 v66, v66
  v_exp_f32 v67, v67
  v_cvt_pk_bf16_f32 v88, v64, v65
  v_cvt_pk_bf16_f32 v89, v66, v67
  v_mfma_f32_32x32x16_bf16 v[48:63], v[148:151], v[20:23], v[48:63]
  buffer_load_dwordx4 v3, s[20:23], s65 offen offset:2048 sc1 lds
  v_exp_f32 v68, v68
  v_exp_f32 v69, v69
  v_exp_f32 v70, v70
  v_exp_f32 v71, v71
  v_cvt_pk_bf16_f32 v90, v68, v69
  v_cvt_pk_bf16_f32 v91, v70, v71
  v_mfma_f32_32x32x16_bf16 a[32:47], v[136:139], v[80:83], a[32:47]
  v_exp_f32 v72, v72
  v_exp_f32 v73, v73
  v_exp_f32 v74, v74
  v_exp_f32 v75, v75
  v_cvt_pk_bf16_f32 v92, v72, v73
  v_cvt_pk_bf16_f32 v93, v74, v75
  v_mfma_f32_32x32x16_bf16 a[32:47], v[140:143], v[84:87], a[32:47]
  v_exp_f32 v76, v76
  v_exp_f32 v77, v77
  v_exp_f32 v78, v78
  v_exp_f32 v79, v79
  v_cvt_pk_bf16_f32 v94, v76, v77
  v_cvt_pk_bf16_f32 v95, v78, v79
  v_mfma_f32_32x32x16_bf16 v[64:79], v[144:147], v[24:27], 0
  v_exp_f32 v48, v48
  v_exp_f32 v49, v49
  v_exp_f32 v50, v50
  v_exp_f32 v51, v51
  v_cvt_pk_bf16_f32 v80, v48, v49
  v_cvt_pk_bf16_f32 v81, v50, v51
  v_mfma_f32_32x32x16_bf16 v[64:79], v[148:151], v[28:31], v[64:79]
  v_exp_f32 v52, v52
  v_exp_f32 v53, v53
  v_exp_f32 v54, v54
  v_exp_f32 v55, v55
  v_cvt_pk_bf16_f32 v82, v52, v53
  v_cvt_pk_bf16_f32 v83, v54, v55
  v_mfma_f32_32x32x16_bf16 a[48:63], v[136:139], v[88:91], a[48:63]
  v_exp_f32 v56, v56
  v_exp_f32 v57, v57
  v_exp_f32 v58, v58
  v_exp_f32 v59, v59
  v_cvt_pk_bf16_f32 v84, v56, v57
  v_cvt_pk_bf16_f32 v85, v58, v59
  v_mfma_f32_32x32x16_bf16 a[48:63], v[140:143], v[92:95], a[48:63]
  v_exp_f32 v60, v60
  v_exp_f32 v61, v61
  v_exp_f32 v62, v62
  v_exp_f32 v63, v63
  v_cvt_pk_bf16_f32 v86, v60, v61
  v_cvt_pk_bf16_f32 v87, v62, v63
  v_mfma_f32_32x32x16_bf16 v[48:63], v[144:147], v[32:35], 0
  v_exp_f32 v64, v64
  v_exp_f32 v65, v65
  v_exp_f32 v66, v66
  v_exp_f32 v67, v67
  v_cvt_pk_bf16_f32 v88, v64, v65
  v_cvt_pk_bf16_f32 v89, v66, v67
  v_mfma_f32_32x32x16_bf16 v[48:63], v[148:151], v[36:39], v[48:63]
  v_exp_f32 v68, v68
  v_exp_f32 v69, v69
  v_exp_f32 v70, v70
  v_exp_f32 v71, v71
  s_waitcnt vmcnt(17)
  v_cvt_pk_bf16_f32 v90, v68, v69
  v_cvt_pk_bf16_f32 v91, v70, v71
  v_mfma_f32_32x32x16_bf16 a[0:15], v[152:155], v[80:83], a[0:15]
  v_exp_f32 v72, v72
  v_exp_f32 v73, v73
  v_exp_f32 v74, v74
  v_exp_f32 v75, v75
  v_cvt_pk_bf16_f32 v92, v72, v73
  v_cvt_pk_bf16_f32 v93, v74, v75
  v_mfma_f32_32x32x16_bf16 a[0:15], v[156:159], v[84:87], a[0:15]
  v_exp_f32 v76, v76
  v_exp_f32 v77, v77
  v_exp_f32 v78, v78
  v_exp_f32 v79, v79
  v_cvt_pk_bf16_f32 v94, v76, v77
  v_cvt_pk_bf16_f32 v95, v78, v79
  v_mfma_f32_32x32x16_bf16 v[64:79], v[144:147], v[40:43], 0
  v_exp_f32 v48, v48
  v_exp_f32 v49, v49
  v_exp_f32 v50, v50
  v_exp_f32 v51, v51
  v_cvt_pk_bf16_f32 v80, v48, v49
  v_cvt_pk_bf16_f32 v81, v50, v51
  v_mfma_f32_32x32x16_bf16 v[64:79], v[148:151], v[44:47], v[64:79]
  v_exp_f32 v52, v52
  v_exp_f32 v53, v53
  v_exp_f32 v54, v54
  v_exp_f32 v55, v55
  v_cvt_pk_bf16_f32 v82, v52, v53
  v_cvt_pk_bf16_f32 v83, v54, v55
  v_mfma_f32_32x32x16_bf16 a[16:31], v[152:155], v[88:91], a[16:31]
  v_exp_f32 v56, v56
  v_exp_f32 v57, v57
  v_exp_f32 v58, v58
  v_exp_f32 v59, v59
  v_cvt_pk_bf16_f32 v84, v56, v57
  v_cvt_pk_bf16_f32 v85, v58, v59
  v_mfma_f32_32x32x16_bf16 a[16:31], v[156:159], v[92:95], a[16:31]
  v_exp_f32 v60, v60
  v_exp_f32 v61, v61
  v_exp_f32 v62, v62
  v_exp_f32 v63, v63
  v_cvt_pk_bf16_f32 v86, v60, v61
  v_cvt_pk_bf16_f32 v87, v62, v63
  v_add_u32 v4, s40, v3
  s_nop 4
  ds_write_b128 v4, a[16:19] offset:0
  v_exp_f32 v64, v64
  v_exp_f32 v65, v65
  v_exp_f32 v66, v66
  v_exp_f32 v67, v67
  v_cvt_pk_bf16_f32 v88, v64, v65
  v_cvt_pk_bf16_f32 v89, v66, v67
  ds_write_b128 v4, a[20:23] offset:1024
  v_exp_f32 v68, v68
  v_exp_f32 v69, v69
  v_exp_f32 v70, v70
  v_exp_f32 v71, v71
  v_cvt_pk_bf16_f32 v90, v68, v69
  v_cvt_pk_bf16_f32 v91, v70, v71
  v_mfma_f32_32x32x16_bf16 a[32:47], v[152:155], v[80:83], a[32:47]
  ds_write_b128 v4, a[24:27] offset:2048
  v_exp_f32 v72, v72
  v_exp_f32 v73, v73
  v_exp_f32 v74, v74
  v_exp_f32 v75, v75
  v_cvt_pk_bf16_f32 v92, v72, v73
  v_cvt_pk_bf16_f32 v93, v74, v75
  v_mfma_f32_32x32x16_bf16 a[32:47], v[156:159], v[84:87], a[32:47]
  ds_write_b128 v4, a[28:31] offset:3072
  v_exp_f32 v76, v76
  v_exp_f32 v77, v77
  v_exp_f32 v78, v78
  v_exp_f32 v79, v79
  v_cvt_pk_bf16_f32 v94, v76, v77
  v_cvt_pk_bf16_f32 v95, v78, v79
  v_mfma_f32_32x32x16_bf16 a[48:63], v[152:155], v[88:91], a[48:63]
  s_nop 0
  v_mfma_f32_32x32x16_bf16 a[48:63], v[156:159], v[92:95], a[48:63]
  v_add_u32 v4, s41, v3
  s_nop 0
  ds_write_b128 v4, a[32:35] offset:0
  ds_write_b128 v4, a[36:39] offset:1024
  ds_write_b128 v4, a[40:43] offset:2048
  ds_write_b128 v4, a[44:47] offset:3072
  s_nop 0
  v_add_u32 v4, s42, v3
  s_nop 3
  ds_write_b128 v4, a[48:51] offset:0
  ds_write_b128 v4, a[52:55] offset:1024
  ds_write_b128 v4, a[56:59] offset:2048
  ds_write_b128 v4, a[60:63] offset:3072
  v_accvgpr_read_b32 v144, a0
  v_accvgpr_read_b32 v145, a1
  v_accvgpr_read_b32 v146, a2
  v_accvgpr_read_b32 v147, a3
  v_accvgpr_read_b32 v148, a4
  v_accvgpr_read_b32 v149, a5
  v_accvgpr_read_b32 v150, a6
  v_accvgpr_read_b32 v151, a7
  v_accvgpr_read_b32 v152, a8
  v_accvgpr_read_b32 v153, a9
  v_accvgpr_read_b32 v154, a10
  v_accvgpr_read_b32 v155, a11
  v_accvgpr_read_b32 v156, a12
  v_accvgpr_read_b32 v157, a13
  v_accvgpr_read_b32 v158, a14
  v_accvgpr_read_b32 v159, a15
  v_accvgpr_read_b32 v96, a28
  v_accvgpr_read_b32 v97, a44
  v_accvgpr_read_b32 v98, a60
  v_mov_b32 v5, 0x5f800000
  v_add_f32 v96, v96, v156
  v_add_f32 v97, v97, v98
  v_add_f32 v96, v96, v97
  v_cmp_nlt_f32 vcc, v96, v5
  s_lshl_b32 s36, s24, 2
  s_add_u32 s36, s36, 90112
  v_mov_b32 v4, s36
  v_mov_b32 v5, vcc_hi
  v_mov_b32 v6, 90112
  ds_write_b32 v4, v5
  v_add_u32 v4, s43, v3
  s_waitcnt lgkmcnt(0)
  s_barrier
  ds_read_b128 v[48:51], v6
  ds_read_b128 v[108:111], v4 offset:3072
  ds_read_b128 v[124:127], v4 offset:7168
  ds_read_b128 v[140:143], v4 offset:11264
  ds_read_b128 v[96:99], v4 offset:0
  ds_read_b128 v[112:115], v4 offset:4096
  ds_read_b128 v[128:131], v4 offset:8192
  ds_read_b128 v[100:103], v4 offset:1024
  ds_read_b128 v[116:119], v4 offset:5120
  ds_read_b128 v[132:135], v4 offset:9216
  ds_read_b128 v[104:107], v4 offset:2048
  ds_read_b128 v[120:123], v4 offset:6144
  ds_read_b128 v[136:139], v4 offset:10240
  s_lshl_b32 s30, s26, 10
  s_add_u32 s30, s30, 26877952
  s_lshl_b32 s26, s26, 2
  s_add_u32 s26, s26, s24
  s_lshl_b32 s26, s26, 5
  s_lshl_b32 s27, s25, 1
  s_add_u32 s26, s26, s27
  s_lshl_b32 s26, s26, 10
  s_add_u32 s27, s26, 9560064
  s_waitcnt lgkmcnt(12)
  v_or3_b32 v5, v48, v49, v50
  v_or_b32 v5, v5, v51
  s_nop 0
  v_readfirstlane_b32 s36, v5
  s_nop 0
  s_cmp_lg_u32 s36, 0
  s_cselect_b32 s36, 1, 0
  s_cmp_gt_u32 s36, s70
  s_cbranch_scc1 B_slow
  s_waitcnt lgkmcnt(9)
  v_pk_add_f32 v[108:109], v[108:109], v[124:125]
  v_pk_add_f32 v[156:157], v[156:157], v[140:141]
  v_pk_add_f32 v[110:111], v[110:111], v[126:127]
  v_pk_add_f32 v[158:159], v[158:159], v[142:143]
  v_pk_add_f32 v[156:157], v[156:157], v[108:109]
  v_pk_add_f32 v[158:159], v[158:159], v[110:111]
  v_mov_b32 v4, v156
  v_mov_b32 v6, v156
  s_nop 1
  v_permlane32_swap_b32 v6, v4
  v_rcp_f32 v4, v4
  s_waitcnt lgkmcnt(6)
  v_pk_add_f32 v[96:97], v[96:97], v[112:113]
  v_pk_add_f32 v[144:145], v[144:145], v[128:129]
  v_pk_add_f32 v[98:99], v[98:99], v[114:115]
  v_pk_add_f32 v[146:147], v[146:147], v[130:131]
  v_pk_add_f32 v[144:145], v[144:145], v[96:97]
  v_pk_add_f32 v[146:147], v[146:147], v[98:99]
  s_waitcnt lgkmcnt(3)
  v_pk_add_f32 v[100:101], v[100:101], v[116:117]
  v_pk_add_f32 v[148:149], v[148:149], v[132:133]
  v_pk_add_f32 v[102:103], v[102:103], v[118:119]
  v_pk_add_f32 v[150:151], v[150:151], v[134:135]
  v_pk_add_f32 v[148:149], v[148:149], v[100:101]
  v_pk_add_f32 v[150:151], v[150:151], v[102:103]
  s_waitcnt lgkmcnt(0)
  v_pk_add_f32 v[104:105], v[104:105], v[120:121]
  v_pk_add_f32 v[152:153], v[152:153], v[136:137]
  v_pk_add_f32 v[106:107], v[106:107], v[122:123]
  v_pk_add_f32 v[154:155], v[154:155], v[138:139]
  v_pk_add_f32 v[152:153], v[152:153], v[104:105]
  v_pk_add_f32 v[154:155], v[154:155], v[106:107]
  v_pk_mul_f32 v[144:145], v[144:145], v[4:5] op_sel_hi:[1,0]
  v_pk_mul_f32 v[146:147], v[146:147], v[4:5] op_sel_hi:[1,0]
  v_pk_mul_f32 v[148:149], v[148:149], v[4:5] op_sel_hi:[1,0]
  v_pk_mul_f32 v[150:151], v[150:151], v[4:5] op_sel_hi:[1,0]
  v_pk_mul_f32 v[152:153], v[152:153], v[4:5] op_sel_hi:[1,0]
  v_pk_mul_f32 v[154:155], v[154:155], v[4:5] op_sel_hi:[1,0]
  v_pk_mul_f32 v[156:157], v[156:157], v[4:5] op_sel_hi:[1,0]
  v_pk_mul_f32 v[158:159], v[158:159], v[4:5] op_sel_hi:[1,0]
  v_cvt_pk_bf16_f32 v16, v144, v145
  v_cvt_pk_bf16_f32 v17, v146, v147
  v_cvt_pk_bf16_f32 v18, v148, v149
  v_cvt_pk_bf16_f32 v19, v150, v151
  v_cvt_pk_bf16_f32 v20, v152, v153
  v_cvt_pk_bf16_f32 v21, v154, v155
  v_cvt_pk_bf16_f32 v22, v156, v157
  v_cvt_pk_bf16_f32 v23, v158, v159
  buffer_store_dwordx4 v[16:19], v3, s[20:23], s27 offen sc1
  buffer_store_dwordx4 v[20:23], v3, s[20:23], s27 offen offset:1024 sc1
  s_waitcnt vmcnt(33)
  v_pk_add_f32 v[224:225], v[224:225], v[238:239]
  v_pk_add_f32 v[226:227], v[226:227], v[240:241]
  v_pk_add_f32 v[228:229], v[228:229], v[242:243]
  v_pk_add_f32 v[230:231], v[230:231], v[244:245]
  v_pk_add_f32 v[232:233], v[232:233], v[246:247]
  v_pk_add_f32 v[234:235], v[234:235], v[248:249]
  v_pk_add_f32 v[236:237], v[236:237], v[250:251]
  v_pk_add_f32 v[224:225], v[224:225], v[230:231]
  v_pk_add_f32 v[226:227], v[226:227], v[232:233]
  v_pk_add_f32 v[228:229], v[228:229], v[234:235]
  v_pk_add_f32 v[224:225], v[224:225], v[226:227]
  v_pk_add_f32 v[228:229], v[228:229], v[236:237]
  v_pk_add_f32 v[224:225], v[224:225], v[228:229]
  v_cvt_pk_bf16_f32 v80, v224, v224
  v_cvt_pk_bf16_f32 v226, v225, v225
  v_and_b32 v227, s34, v80
  v_and_b32 v226, s34, v226
  v_sub_f32 v227, v224, v227
  v_sub_f32 v228, v225, v226
  v_cvt_pk_bf16_f32 v81, v227, v226
  v_cvt_pk_bf16_f32 v82, v226, v228
  s_and_b32 s28, s24, 1
  s_lshl_b32 s29, s28, 14
  s_lshr_b32 s27, s24, 1
  s_add_u32 s44, s67, s27
  s_mov_b32 s46, s72
  s_lshl_b32 s48, s44, 15
  s_add_u32 s48, s48, s29
  s_add_u32 s48, s48, 9560064
  s_lshl_b32 s31, s69, 10
  s_add_u32 s31, s31, 26877952
  v_mov_b32 v15, v10
  v_lshrrev_b32 v13, 5, v0
  v_and_b32 v5, 31, v0
  v_lshlrev_b32 v13, 10, v13
  v_lshl_add_u32 v13, v5, 4, v13
  v_add_u32 v13, 143360, v13
  v_mov_b32 v83, 0
  v_mov_b32 v84, 0
  v_mov_b32 v85, 0
  v_mov_b32 v86, 0
  v_mov_b32 v87, 0
  s_mov_b32 s66, s25
  s_lshl_b32 s66, s66, 2
  s_add_u32 s66, s66, s30
  v_lshlrev_b32 v4, 8, v1
  v_mov_b32 v5, 0x5a17c0de
  s_waitcnt vmcnt(0) lgkmcnt(0)
  s_barrier
  s_cmp_lg_u32 s24, 0
  s_cbranch_scc1 Lsig4
  s_mov_b64 exec, 0xf
  buffer_store_dword v5, v4, s[20:23], s66 offen sc1
  s_mov_b64 exec, -1
Lsig4:
  s_cmp_lg_u32 s62, 1073741824
  s_cbranch_scc1 C_e1ok
  s_mov_b32 s66, 0
C_e1p:
  buffer_load_dwordx4 v[252:255], v8, s[20:23], s87 offen sc1
  s_add_u32 s66, s66, 1
  s_waitcnt vmcnt(0)
  v_xor_b32 v252, v9, v252
  v_xor_b32 v253, v9, v253
  v_xor_b32 v254, v9, v254
  v_xor_b32 v255, v9, v255
  v_or3_b32 v5, v252, v253, v254
  v_or_b32 v5, v5, v255
  v_cmp_ne_u32 vcc, 0, v5
  s_cmp_gt_u32 s66, 400000
  s_cbranch_scc1 C_e1x
  s_cmp_lg_u64 vcc, 0
  s_cbranch_scc1 C_e1p
C_e1x:
  s_add_u32 s64, s58, 0
  s_mov_b32 m0, s64
  s_add_u32 s65, s57, 0
  buffer_load_dwordx4 v3, s[20:23], s65 offen offset:0 sc1 lds
  buffer_load_dwordx4 v3, s[20:23], s65 offen offset:1024 sc1 lds
  buffer_load_dwordx4 v3, s[20:23], s65 offen offset:2048 sc1 lds
  buffer_load_dwordx4 v3, s[20:23], s65 offen offset:3072 sc1 lds
  s_add_u32 s64, s64, 4096
  s_mov_b32 m0, s64
  s_add_u32 s65, s65, 4096
  buffer_load_dwordx4 v3, s[20:23], s65 offen offset:0 sc1 lds
  buffer_load_dwordx4 v3, s[20:23], s65 offen offset:1024 sc1 lds
  buffer_load_dwordx4 v3, s[20:23], s65 offen offset:2048 sc1 lds
  s_add_u32 s64, s58, 28672
  s_mov_b32 m0, s64
  s_add_u32 s65, s57, 28672
  buffer_load_dwordx4 v3, s[20:23], s65 offen offset:0 sc1 lds
  buffer_load_dwordx4 v3, s[20:23], s65 offen offset:1024 sc1 lds
  buffer_load_dwordx4 v3, s[20:23], s65 offen offset:2048 sc1 lds
  buffer_load_dwordx4 v3, s[20:23], s65 offen offset:3072 sc1 lds
  s_add_u32 s64, s64, 4096
  s_mov_b32 m0, s64
  s_add_u32 s65, s65, 4096
  buffer_load_dwordx4 v3, s[20:23], s65 offen offset:0 sc1 lds
  buffer_load_dwordx4 v3, s[20:23], s65 offen offset:1024 sc1 lds
  buffer_load_dwordx4 v3, s[20:23], s65 offen offset:2048 sc1 lds
  s_add_u32 s64, s58, 57344
  s_mov_b32 m0, s64
  s_add_u32 s65, s57, 57344
  buffer_load_dwordx4 v3, s[20:23], s65 offen offset:0 sc1 lds
  buffer_load_dwordx4 v3, s[20:23], s65 offen offset:1024 sc1 lds
  buffer_load_dwordx4 v3, s[20:23], s65 offen offset:2048 sc1 lds
  buffer_load_dwordx4 v3, s[20:23], s65 offen offset:3072 sc1 lds
  s_add_u32 s64, s64, 4096
  s_mov_b32 m0, s64
  s_add_u32 s65, s65, 4096
  buffer_load_dwordx4 v3, s[20:23], s65 offen offset:0 sc1 lds
  buffer_load_dwordx4 v3, s[20:23], s65 offen offset:1024 sc1 lds
  buffer_load_dwordx4 v3, s[20:23], s65 offen offset:2048 sc1 lds
  s_mov_b32 s71, s59
  buffer_load_dwordx2 v[96:97], v14, s[20:23], s71 offen sc1
  s_add_u32 s71, s71, 28672
  buffer_load_dwordx2 v[98:99], v14, s[20:23], s71 offen sc1
  s_add_u32 s71, s71, 28672
  buffer_load_dwordx2 v[100:101], v14, s[20:23], s71 offen sc1
  s_add_u32 s71, s71, 28672
  buffer_load_dwordx2 v[102:103], v14, s[20:23], s71 offen sc1
  s_add_u32 s71, s71, 28672
  buffer_load_dwordx2 v[104:105], v14, s[20:23], s71 offen sc1
  s_add_u32 s71, s71, 28672
  buffer_load_dwordx2 v[106:107], v14, s[20:23], s71 offen sc1
  s_add_u32 s71, s71, 28672
  buffer_load_dwordx2 v[108:109], v14, s[20:23], s71 offen sc1
  s_add_u32 s71, s71, 28672
  buffer_load_dwordx2 v[110:111], v14, s[20:23], s71 offen sc1
  s_add_u32 s71, s71, 28672
  buffer_load_dwordx2 v[112:113], v14, s[20:23], s71 offen sc1
  s_add_u32 s71, s71, 28672
  buffer_load_dwordx2 v[114:115], v14, s[20:23], s71 offen sc1
  s_add_u32 s71, s71, 28672
  buffer_load_dwordx2 v[116:117], v14, s[20:23], s71 offen sc1
  s_add_u32 s71, s71, 28672
  buffer_load_dwordx2 v[118:119], v14, s[20:23], s71 offen sc1
  s_add_u32 s71, s71, 28672
  buffer_load_dwordx2 v[120:121], v14, s[20:23], s71 offen sc1
  s_add_u32 s71, s71, 28672
  buffer_load_dwordx2 v[122:123], v14, s[20:23], s71 offen sc1
  s_waitcnt vmcnt(0)
  v_pk_add_f32 v[96:97], v[96:97], v[110:111]
  v_pk_add_f32 v[98:99], v[98:99], v[112:113]
  v_pk_add_f32 v[100:101], v[100:101], v[114:115]
  v_pk_add_f32 v[102:103], v[102:103], v[116:117]
  v_pk_add_f32 v[104:105], v[104:105], v[118:119]
  v_pk_add_f32 v[106:107], v[106:107], v[120:121]
  v_pk_add_f32 v[108:109], v[108:109], v[122:123]
  v_pk_add_f32 v[96:97], v[96:97], v[102:103]
  v_pk_add_f32 v[98:99], v[98:99], v[104:105]
  v_pk_add_f32 v[100:101], v[100:101], v[106:107]
  v_pk_add_f32 v[96:97], v[96:97], v[98:99]
  v_pk_add_f32 v[100:101], v[100:101], v[108:109]
  v_pk_add_f32 v[96:97], v[96:97], v[100:101]
  v_cvt_pk_bf16_f32 v80, v96, v96
  v_cvt_pk_bf16_f32 v98, v97, v97
  v_and_b32 v99, s34, v80
  v_and_b32 v98, s34, v98
  v_sub_f32 v99, v96, v99
  v_sub_f32 v100, v97, v98
  v_cvt_pk_bf16_f32 v81, v99, v98
  v_cvt_pk_bf16_f32 v82, v98, v100
C_e1ok:
  ds_write_b128 v13, v[80:83]
  ds_write_b128 v13, v[84:87] offset:512
  s_cmp_ge_u32 s61, 28
  s_cbranch_scc1 C_skip
  s_cmp_eq_u32 s24, 3
  s_cbranch_scc1 Lsd5
  s_add_u32 s64, s58, 86016
  s_mov_b32 m0, s64
  s_add_u32 s65, s57, 86016
  buffer_load_dwordx4 v3, s[20:23], s65 offen offset:0 sc1 lds
  buffer_load_dwordx4 v3, s[20:23], s65 offen offset:1024 sc1 lds
  buffer_load_dwordx4 v3, s[20:23], s65 offen offset:2048 sc1 lds
  buffer_load_dwordx4 v3, s[20:23], s65 offen offset:3072 sc1 lds
  s_add_u32 s64, s64, 4096
  s_mov_b32 m0, s64
  s_add_u32 s65, s65, 4096
  buffer_load_dwordx4 v3, s[20:23], s65 offen offset:0 sc1 lds
  buffer_load_dwordx4 v3, s[20:23], s65 offen offset:1024 sc1 lds
  buffer_load_dwordx4 v3, s[20:23], s65 offen offset:2048 sc1 lds
Lsd5:
  s_cmp_lg_u32 s24, 3
  s_cbranch_scc1 Lpd8
  s_add_u32 s66, s31, s63
  v_lshl_add_u32 v4, v1, 2, s66
  s_mov_b64 exec, 0xffff
  v_mov_b32 v6, 0x5a17c0de
  s_mov_b32 s66, 0
Lpoll7:
  buffer_load_dword v5, v4, s[20:23], 0 offen sc1
  s_add_u32 s66, s66, 1
  s_waitcnt vmcnt(0)
  v_cmp_ne_u32 vcc, v6, v5
  s_cmp_gt_u32 s66, 400000
  s_cbranch_scc1 Lpoll7x
  s_cmp_lg_u64 vcc, 0
  s_cbranch_scc1 Lpoll7
Lpoll7x:
  s_mov_b64 exec, -1
Lpd8:
  s_barrier
  s_cmp_lg_u32 s24, 3
  s_cbranch_scc1 Lsd6
  s_add_u32 s64, s58, 86016
  s_mov_b32 m0, s64
  s_add_u32 s65, s57, 86016
  buffer_load_dwordx4 v3, s[20:23], s65 offen offset:0 sc1 lds
  buffer_load_dwordx4 v3, s[20:23], s65 offen offset:1024 sc1 lds
  buffer_load_dwordx4 v3, s[20:23], s65 offen offset:2048 sc1 lds
  buffer_load_dwordx4 v3, s[20:23], s65 offen offset:3072 sc1 lds
  s_add_u32 s64, s64, 4096
  s_mov_b32 m0, s64
  s_add_u32 s65, s65, 4096
  buffer_load_dwordx4 v3, s[20:23], s65 offen offset:0 sc1 lds
  buffer_load_dwordx4 v3, s[20:23], s65 offen offset:1024 sc1 lds
  buffer_load_dwordx4 v3, s[20:23], s65 offen offset:2048 sc1 lds
Lsd6:
  buffer_load_dwordx4 v[96:99], v3, s[20:23], s48 offen offset:0 sc1
  buffer_load_dwordx4 v[100:103], v3, s[20:23], s48 offen offset:1024 sc1
  buffer_load_dwordx4 v[104:107], v3, s[20:23], s48 offen offset:2048 sc1
  buffer_load_dwordx4 v[108:111], v3, s[20:23], s48 offen offset:3072 sc1
  s_add_u32 s48, s48, 4096
  buffer_load_dwordx4 v[112:115], v3, s[20:23], s48 offen offset:0 sc1
  buffer_load_dwordx4 v[116:119], v3, s[20:23], s48 offen offset:1024 sc1
  buffer_load_dwordx4 v[120:123], v3, s[20:23], s48 offen offset:2048 sc1
  buffer_load_dwordx4 v[124:127], v3, s[20:23], s48 offen offset:3072 sc1
  s_add_u32 s48, s48, 4096
  buffer_load_dwordx4 v[128:131], v3, s[20:23], s48 offen offset:0 sc1
  buffer_load_dwordx4 v[132:135], v3, s[20:23], s48 offen offset:1024 sc1
  buffer_load_dwordx4 v[136:139], v3, s[20:23], s48 offen offset:2048 sc1
  buffer_load_dwordx4 v[140:143], v3, s[20:23], s48 offen offset:3072 sc1
  s_add_u32 s48, s48, 4096
  buffer_load_dwordx4 v[144:147], v3, s[20:23], s48 offen offset:0 sc1
  buffer_load_dwordx4 v[148:151], v3, s[20:23], s48 offen offset:1024 sc1
  buffer_load_dwordx4 v[152:155], v3, s[20:23], s48 offen offset:2048 sc1
  buffer_load_dwordx4 v[156:159], v3, s[20:23], s48 offen offset:3072 sc1
  v_accvgpr_read_b32 v48, a128
  v_accvgpr_read_b32 v49, a129
  v_accvgpr_read_b32 v50, a130
  v_accvgpr_read_b32 v51, a131
  v_accvgpr_read_b32 v52, a132
  v_accvgpr_read_b32 v53, a133
  v_accvgpr_read_b32 v54, a134
  v_accvgpr_read_b32 v55, a135
  v_accvgpr_read_b32 v56, a136
  v_accvgpr_read_b32 v57, a137
  v_accvgpr_read_b32 v58, a138
  v_accvgpr_read_b32 v59, a139
  v_accvgpr_read_b32 v60, a140
  v_accvgpr_read_b32 v61, a141
  v_accvgpr_read_b32 v62, a142
  v_accvgpr_read_b32 v63, a143
  v_accvgpr_read_b32 v64, a144
  v_accvgpr_read_b32 v65, a145
  v_accvgpr_read_b32 v66, a146
  v_accvgpr_read_b32 v67, a147
  v_accvgpr_read_b32 v68, a148
  v_accvgpr_read_b32 v69, a149
  v_accvgpr_read_b32 v70, a150
  v_accvgpr_read_b32 v71, a151
  s_xor_b32 s27, s24, 1
  s_lshl_b32 s27, s27, 12
  s_add_u32 s27, s27, 114688
  v_add_u32 v4, s27, v3
  s_lshl_b32 s27, s24, 12
  s_add_u32 s27, s27, 114688
  v_add_u32 v5, s27, v3
  s_mul_i32 s29, s44, 28672
  s_lshl_b32 s30, s46, 11
  s_add_u32 s29, s29, s30
  s_add_u32 s29, s29, 12115968
  s_lshl_b32 s30, s69, 10
  s_add_u32 s30, s30, 26894336
  v_lshlrev_b32 v6, 2, v1
  s_mul_i32 s27, s44, 3584
  s_lshl_b32 s28, s46, 8
  s_add_u32 s28, s28, s27
  s_add_u32 s28, s28, 17571840
  s_waitcnt lgkmcnt(0)
  v_permlane32_swap_b32 v48, v50
  v_permlane32_swap_b32 v49, v51
  v_permlane32_swap_b32 v52, v54
  v_permlane32_swap_b32 v53, v55
  v_lshlrev_b32 v72, 16, v48
  v_and_b32 v73, s34, v48
  v_lshlrev_b32 v74, 16, v49
  v_and_b32 v75, s34, v49
  v_lshlrev_b32 v76, 16, v52
  v_and_b32 v77, s34, v52
  v_lshlrev_b32 v78, 16, v53
  v_and_b32 v79, s34, v53
  v_lshlrev_b32 v80, 16, v50
  v_and_b32 v81, s34, v50
  v_lshlrev_b32 v82, 16, v51
  v_and_b32 v83, s34, v51
  v_lshlrev_b32 v84, 16, v54
  v_and_b32 v85, s34, v54
  v_lshlrev_b32 v86, 16, v55
  v_and_b32 v87, s34, v55
  s_waitcnt vmcnt(15)
  v_mfma_f32_32x32x16_bf16 v[32:47], a[64:67], v[96:99], 0
  v_mfma_f32_32x32x16_bf16 v[16:31], v[160:163], v[96:99], 0
  s_waitcnt vmcnt(14)
  v_mfma_f32_32x32x16_bf16 v[32:47], a[68:71], v[100:103], v[32:47]
  v_mfma_f32_32x32x16_bf16 v[16:31], v[164:167], v[100:103], v[16:31]
  s_waitcnt vmcnt(13)
  v_mfma_f32_32x32x16_bf16 v[32:47], a[72:75], v[104:107], v[32:47]
  v_mfma_f32_32x32x16_bf16 v[16:31], v[168:171], v[104:107], v[16:31]
  s_waitcnt vmcnt(12)
  v_mfma_f32_32x32x16_bf16 v[32:47], a[76:79], v[108:111], v[32:47]
  v_mfma_f32_32x32x16_bf16 v[16:31], v[172:175], v[108:111], v[16:31]
  s_waitcnt vmcnt(11)
  v_mfma_f32_32x32x16_bf16 v[32:47], a[80:83], v[112:115], v[32:47]
  v_mfma_f32_32x32x16_bf16 v[16:31], v[176:179], v[112:115], v[16:31]
  s_waitcnt vmcnt(10)
  v_mfma_f32_32x32x16_bf16 v[32:47], a[84:87], v[116:119], v[32:47]
  v_mfma_f32_32x32x16_bf16 v[16:31], v[180:183], v[116:119], v[16:31]
  s_waitcnt vmcnt(9)
  v_mfma_f32_32x32x16_bf16 v[32:47], a[88:91], v[120:123], v[32:47]
  v_mfma_f32_32x32x16_bf16 v[16:31], v[184:187], v[120:123], v[16:31]
  s_waitcnt vmcnt(8)
  v_mfma_f32_32x32x16_bf16 v[32:47], a[92:95], v[124:127], v[32:47]
  v_mfma_f32_32x32x16_bf16 v[16:31], v[188:191], v[124:127], v[16:31]
  s_waitcnt vmcnt(7)
  v_mfma_f32_32x32x16_bf16 v[32:47], a[96:99], v[128:131], v[32:47]
  v_mfma_f32_32x32x16_bf16 v[16:31], v[192:195], v[128:131], v[16:31]
  s_waitcnt vmcnt(6)
  v_mfma_f32_32x32x16_bf16 v[32:47], a[100:103], v[132:135], v[32:47]
  v_mfma_f32_32x32x16_bf16 v[16:31], v[196:199], v[132:135], v[16:31]
  s_waitcnt vmcnt(5)
  v_mfma_f32_32x32x16_bf16 v[32:47], a[104:107], v[136:139], v[32:47]
  v_mfma_f32_32x32x16_bf16 v[16:31], v[200:203], v[136:139], v[16:31]
  s_waitcnt vmcnt(4)
  v_mfma_f32_32x32x16_bf16 v[32:47], a[108:111], v[140:143], v[32:47]
  v_mfma_f32_32x32x16_bf16 v[16:31], v[204:207], v[140:143], v[16:31]
  s_waitcnt vmcnt(3)
  v_mfma_f32_32x32x16_bf16 v[32:47], a[112:115], v[144:147], v[32:47]
  v_mfma_f32_32x32x16_bf16 v[16:31], v[208:211], v[144:147], v[16:31]
  s_waitcnt vmcnt(2)
  v_mfma_f32_32x32x16_bf16 v[32:47], a[116:119], v[148:151], v[32:47]
  v_mfma_f32_32x32x16_bf16 v[16:31], v[212:215], v[148:151], v[16:31]
  s_waitcnt vmcnt(1)
  v_mfma_f32_32x32x16_bf16 v[32:47], a[120:123], v[152:155], v[32:47]
  v_mfma_f32_32x32x16_bf16 v[16:31], v[216:219], v[152:155], v[16:31]
  s_waitcnt vmcnt(0)
  v_mfma_f32_32x32x16_bf16 v[32:47], a[124:127], v[156:159], v[32:47]
  v_mfma_f32_32x32x16_bf16 v[16:31], v[220:223], v[156:159], v[16:31]
  s_nop 10
  ds_write_b128 v4, v[32:35] offset:0
  ds_write_b128 v4, v[36:39] offset:1024
  ds_write_b128 v4, v[40:43] offset:2048
  ds_write_b128 v4, v[44:47] offset:3072
  s_waitcnt lgkmcnt(0)
  s_barrier
  ds_read_b128 v[32:35], v5 offset:0
  ds_read_b128 v[36:39], v5 offset:1024
  ds_read_b128 v[40:43], v5 offset:2048
  ds_read_b128 v[44:47], v5 offset:3072
  s_waitcnt lgkmcnt(3)
  v_pk_add_f32 v[16:17], v[16:17], v[32:33]
  v_pk_add_f32 v[18:19], v[18:19], v[34:35]
  v_pk_fma_f32 v[72:73], v[16:17], v[56:57], v[72:73]
  v_pk_fma_f32 v[74:75], v[18:19], v[58:59], v[74:75]
  v_cvt_pk_bf16_f32 v88, v72, v73
  v_cvt_pk_bf16_f32 v89, v74, v75
  s_waitcnt lgkmcnt(2)
  v_pk_add_f32 v[20:21], v[20:21], v[36:37]
  v_pk_add_f32 v[22:23], v[22:23], v[38:39]
  v_pk_fma_f32 v[76:77], v[20:21], v[60:61], v[76:77]
  v_pk_fma_f32 v[78:79], v[22:23], v[62:63], v[78:79]
  v_cvt_pk_bf16_f32 v90, v76, v77
  v_cvt_pk_bf16_f32 v91, v78, v79
  buffer_store_dwordx4 v[88:91], v3, s[20:23], s29 offen offset:0 sc1
  s_waitcnt lgkmcnt(1)
  v_pk_add_f32 v[24:25], v[24:25], v[40:41]
  v_pk_add_f32 v[26:27], v[26:27], v[42:43]
  v_pk_fma_f32 v[80:81], v[24:25], v[64:65], v[80:81]
  v_pk_fma_f32 v[82:83], v[26:27], v[66:67], v[82:83]
  v_cvt_pk_bf16_f32 v92, v80, v81
  v_cvt_pk_bf16_f32 v93, v82, v83
  s_waitcnt lgkmcnt(0)
  v_pk_add_f32 v[28:29], v[28:29], v[44:45]
  v_pk_add_f32 v[30:31], v[30:31], v[46:47]
  v_pk_fma_f32 v[84:85], v[28:29], v[68:69], v[84:85]
  v_pk_fma_f32 v[86:87], v[30:31], v[70:71], v[86:87]
  v_cvt_pk_bf16_f32 v94, v84, v85
  v_cvt_pk_bf16_f32 v95, v86, v87
  buffer_store_dwordx4 v[92:95], v3, s[20:23], s29 offen offset:1024 sc1
  v_pk_add_f32 v[16:17], v[72:73], v[74:75]
  v_pk_mul_f32 v[18:19], v[72:73], v[72:73]
  v_pk_add_f32 v[20:21], v[76:77], v[78:79]
  v_pk_mul_f32 v[22:23], v[74:75], v[74:75]
  v_pk_fma_f32 v[18:19], v[76:77], v[76:77], v[18:19]
  v_pk_fma_f32 v[22:23], v[78:79], v[78:79], v[22:23]
  v_pk_add_f32 v[16:17], v[16:17], v[80:81]
  v_pk_fma_f32 v[18:19], v[80:81], v[80:81], v[18:19]
  v_pk_add_f32 v[20:21], v[20:21], v[82:83]
  v_pk_fma_f32 v[22:23], v[82:83], v[82:83], v[22:23]
  v_pk_add_f32 v[16:17], v[16:17], v[84:85]
  v_pk_fma_f32 v[18:19], v[84:85], v[84:85], v[18:19]
  v_pk_add_f32 v[20:21], v[20:21], v[86:87]
  v_pk_fma_f32 v[22:23], v[86:87], v[86:87], v[22:23]
  v_pk_add_f32 v[16:17], v[16:17], v[20:21]
  v_pk_add_f32 v[18:19], v[18:19], v[22:23]
  v_add_f32 v16, v16, v17
  v_add_f32 v18, v18, v19
  s_nop 1
  v_permlane32_swap_b32 v16, v18
  v_add_f32 v16, v16, v18
  buffer_store_dword v16, v6, s[20:23], s28 offen sc1
  s_bfe_u32 s66, s67, 0x10001
  s_mul_i32 s66, s66, 7
  s_lshr_b32 s27, s68, 1
  s_add_u32 s66, s66, s27
  s_lshl_b32 s66, s66, 2
  s_add_u32 s66, s66, s30
  v_lshlrev_b32 v4, 8, v1
  v_mov_b32 v5, 0x5a17c0de
  s_lshl_b32 s26, s55, 2
  s_add_u32 s26, s26, s24
  s_mul_i32 s27, s26, 28672
  s_add_u32 s27, s27, 12115968
  s_mul_i32 s38, s26, 114688
  s_mul_i32 s39, s56, 7168
  s_add_u32 s38, s38, s39
  s_add_u32 s38, s38, 17915904
  s_lshl_b32 s31, s55, 10
  s_add_u32 s31, s31, 26894336
  s_lshl_b32 s30, s55, 10
  s_lshr_b32 s36, s56, 2
  s_lshl_b32 s36, s36, 8
  s_add_u32 s30, s30, s36
  s_and_b32 s36, s56, 3
  s_lshl_b32 s36, s36, 4
  s_add_u32 s30, s30, s36
  s_lshl_b32 s36, s24, 2
  s_add_u32 s30, s30, s36
  s_add_u32 s51, s30, 26927104
  s_add_u32 s30, s30, 26910720
  v_mov_b32 v254, 0x5a17c0de
  v_lshlrev_b32 v255, 7, v1
  s_lshl_b32 s36, s69, 10
  s_and_b32 s37, s61, 1
  s_lshl_b32 s37, s37, 7
  s_add_u32 s36, s36, s37
  s_lshl_b32 s37, s24, 8
  s_add_u32 s36, s36, s37
  s_and_b32 s37, s67, 3
  s_lshl_b32 s37, s37, 2
  s_add_u32 s36, s36, s37
  v_bfe_u32 v243, v1, 1, 2
  v_lshlrev_b32 v243, 4, v243
  v_and_b32 v244, 1, v1
  v_lshl_add_u32 v243, v244, 2, v243
  v_add_u32 v243, s36, v243
  s_mov_b32 s52, 26927104
  s_mov_b32 s54, 26910720
  s_xor_b32 s45, s44, 1
  s_mul_i32 s36, s24, 28672
  s_mul_i32 s48, s44, 114688
  s_mul_i32 s49, s45, 114688
  s_add_u32 s37, s36, 17915904
  s_add_u32 s48, s48, s37
  s_add_u32 s49, s49, s37
  v_lshlrev_b32 v8, 2, v1
  s_mul_i32 s28, s26, 3584
  s_add_u32 s28, s28, 17571840
  s_waitcnt vmcnt(0)
  s_barrier
  s_cmp_lg_u32 s24, 0
  s_cbranch_scc1 Lsig9
  s_mov_b64 exec, 0xf
  buffer_store_dword v5, v4, s[20:23], s66 offen sc1
  s_mov_b64 exec, -1
Lsig9:
  s_branch C_join
C_skip:
  s_add_u32 s64, s58, 86016
  s_mov_b32 m0, s64
  s_add_u32 s65, s57, 86016
  buffer_load_dwordx4 v3, s[20:23], s65 offen offset:0 sc1 lds
  buffer_load_dwordx4 v3, s[20:23], s65 offen offset:1024 sc1 lds
  buffer_load_dwordx4 v3, s[20:23], s65 offen offset:2048 sc1 lds
  buffer_load_dwordx4 v3, s[20:23], s65 offen offset:3072 sc1 lds
  s_add_u32 s64, s64, 4096
  s_mov_b32 m0, s64
  s_add_u32 s65, s65, 4096
  buffer_load_dwordx4 v3, s[20:23], s65 offen offset:0 sc1 lds
  buffer_load_dwordx4 v3, s[20:23], s65 offen offset:1024 sc1 lds
  buffer_load_dwordx4 v3, s[20:23], s65 offen offset:2048 sc1 lds
  s_lshl_b32 s26, s55, 2
  s_add_u32 s26, s26, s24
  s_mul_i32 s27, s26, 28672
  s_add_u32 s27, s27, 12115968
  s_mul_i32 s38, s26, 114688
  s_mul_i32 s39, s56, 7168
  s_add_u32 s38, s38, s39
  s_add_u32 s38, s38, 17915904
  s_lshl_b32 s31, s55, 10
  s_add_u32 s31, s31, 26894336
  s_lshl_b32 s30, s55, 10
  s_lshr_b32 s36, s56, 2
  s_lshl_b32 s36, s36, 8
  s_add_u32 s30, s30, s36
  s_and_b32 s36, s56, 3
  s_lshl_b32 s36, s36, 4
  s_add_u32 s30, s30, s36
  s_lshl_b32 s36, s24, 2
  s_add_u32 s30, s30, s36
  s_add_u32 s51, s30, 26927104
  s_add_u32 s30, s30, 26910720
  v_mov_b32 v254, 0x5a17c0de
  v_lshlrev_b32 v255, 7, v1
  s_lshl_b32 s36, s69, 10
  s_and_b32 s37, s61, 1
  s_lshl_b32 s37, s37, 7
  s_add_u32 s36, s36, s37
  s_lshl_b32 s37, s24, 8
  s_add_u32 s36, s36, s37
  s_and_b32 s37, s67, 3
  s_lshl_b32 s37, s37, 2
  s_add_u32 s36, s36, s37
  v_bfe_u32 v243, v1, 1, 2
  v_lshlrev_b32 v243, 4, v243
  v_and_b32 v244, 1, v1
  v_lshl_add_u32 v243, v244, 2, v243
  v_add_u32 v243, s36, v243
  s_mov_b32 s52, 26927104
  s_mov_b32 s54, 26910720
  s_xor_b32 s45, s44, 1
  s_mul_i32 s36, s24, 28672
  s_mul_i32 s48, s44, 114688
  s_mul_i32 s49, s45, 114688
  s_add_u32 s37, s36, 17915904
  s_add_u32 s48, s48, s37
  s_add_u32 s49, s49, s37
  v_lshlrev_b32 v8, 2, v1
  s_mul_i32 s28, s26, 3584
  s_add_u32 s28, s28, 17571840
  s_waitcnt vmcnt(0)
C_join:
  s_cmp_eq_u32 s24, 3
  s_cbranch_scc1 Lsd10
  s_add_u32 s64, s58, 114688
  s_mov_b32 m0, s64
  s_add_u32 s65, s57, 114688
  buffer_load_dwordx4 v3, s[20:23], s65 offen offset:0 sc1 lds
  buffer_load_dwordx4 v3, s[20:23], s65 offen offset:1024 sc1 lds
  buffer_load_dwordx4 v3, s[20:23], s65 offen offset:2048 sc1 lds
  buffer_load_dwordx4 v3, s[20:23], s65 offen offset:3072 sc1 lds
  s_add_u32 s64, s64, 4096
  s_mov_b32 m0, s64
  s_add_u32 s65, s65, 4096
  buffer_load_dwordx4 v3, s[20:23], s65 offen offset:0 sc1 lds
  buffer_load_dwordx4 v3, s[20:23], s65 offen offset:1024 sc1 lds
  buffer_load_dwordx4 v3, s[20:23], s65 offen offset:2048 sc1 lds
Lsd10:
  s_cmp_lg_u32 s24, 3
  s_cbranch_scc1 Lpd13
  s_add_u32 s66, s31, s63
  v_lshl_add_u32 v4, v1, 2, s66
  s_mov_b64 exec, 0x3fff
  v_mov_b32 v6, 0x5a17c0de
  s_mov_b32 s66, 0
Lpoll12:
  buffer_load_dword v5, v4, s[20:23], 0 offen sc1
  s_add_u32 s66, s66, 1
  s_waitcnt vmcnt(0)
  v_cmp_ne_u32 vcc, v6, v5
  s_cmp_gt_u32 s66, 400000
  s_cbranch_scc1 Lpoll12x
  s_cmp_lg_u64 vcc, 0
  s_cbranch_scc1 Lpoll12
Lpoll12x:
  s_mov_b64 exec, -1
Lpd13:
  v_add_u32 v6, 57344, v3
  v_add_u32 v5, 143360, v3
  v_add_u32 v4, 114688, v3
  s_waitcnt lgkmcnt(0)
  s_barrier
  s_cmp_lg_u32 s24, 3
  s_cbranch_scc1 Lsd11
  s_add_u32 s64, s58, 114688
  s_mov_b32 m0, s64
  s_add_u32 s65, s57, 114688
  buffer_load_dwordx4 v3, s[20:23], s65 offen offset:0 sc1 lds
  buffer_load_dwordx4 v3, s[20:23], s65 offen offset:1024 sc1 lds
  buffer_load_dwordx4 v3, s[20:23], s65 offen offset:2048 sc1 lds
  buffer_load_dwordx4 v3, s[20:23], s65 offen offset:3072 sc1 lds
  s_add_u32 s64, s64, 4096
  s_mov_b32 m0, s64
  s_add_u32 s65, s65, 4096
  buffer_load_dwordx4 v3, s[20:23], s65 offen offset:0 sc1 lds
  buffer_load_dwordx4 v3, s[20:23], s65 offen offset:1024 sc1 lds
  buffer_load_dwordx4 v3, s[20:23], s65 offen offset:2048 sc1 lds
Lsd11:
  s_add_u32 s36, s27, 0
  buffer_load_dwordx4 v[64:67], v3, s[20:23], s36 offen offset:0 sc1
  buffer_load_dwordx4 v[68:71], v3, s[20:23], s36 offen offset:1024 sc1
  buffer_load_dwordx4 v[72:75], v3, s[20:23], s36 offen offset:2048 sc1
  buffer_load_dwordx4 v[76:79], v3, s[20:23], s36 offen offset:3072 sc1
  s_add_u32 s36, s27, 4096
  buffer_load_dwordx4 v[80:83], v3, s[20:23], s36 offen offset:0 sc1
  buffer_load_dwordx4 v[84:87], v3, s[20:23], s36 offen offset:1024 sc1
  buffer_load_dwordx4 v[88:91], v3, s[20:23], s36 offen offset:2048 sc1
  buffer_load_dwordx4 v[92:95], v3, s[20:23], s36 offen offset:3072 sc1
  s_add_u32 s36, s27, 8192
  buffer_load_dwordx4 v[96:99], v3, s[20:23], s36 offen offset:0 sc1
  buffer_load_dwordx4 v[100:103], v3, s[20:23], s36 offen offset:1024 sc1
  buffer_load_dwordx4 v[104:107], v3, s[20:23], s36 offen offset:2048 sc1
  buffer_load_dwordx4 v[108:111], v3, s[20:23], s36 offen offset:3072 sc1
  buffer_load_dword v224, v8, s[20:23], s28 offen offset:0 sc1
  buffer_load_dword v225, v8, s[20:23], s28 offen offset:256 sc1
  buffer_load_dword v226, v8, s[20:23], s28 offen offset:512 sc1
  buffer_load_dword v227, v8, s[20:23], s28 offen offset:768 sc1
  buffer_load_dword v228, v8, s[20:23], s28 offen offset:1024 sc1
  buffer_load_dword v229, v8, s[20:23], s28 offen offset:1280 sc1
  buffer_load_dword v230, v8, s[20:23], s28 offen offset:1536 sc1
  buffer_load_dword v231, v8, s[20:23], s28 offen offset:1792 sc1
  buffer_load_dword v232, v8, s[20:23], s28 offen offset:2048 sc1
  buffer_load_dword v233, v8, s[20:23], s28 offen offset:2304 sc1
  buffer_load_dword v234, v8, s[20:23], s28 offen offset:2560 sc1
  buffer_load_dword v235, v8, s[20:23], s28 offen offset:2816 sc1
  buffer_load_dword v236, v8, s[20:23], s28 offen offset:3072 sc1
  buffer_load_dword v237, v8, s[20:23], s28 offen offset:3328 sc1
  ds_read_b128 v[176:179], v3 offset:0
  ds_read_b128 v[180:183], v3 offset:28672
  ds_read_b128 v[184:187], v6 offset:0
  ds_read_b128 v[188:191], v3 offset:1024
  ds_read_b128 v[192:195], v3 offset:29696
  ds_read_b128 v[196:199], v6 offset:1024
  ds_read_b128 v[200:203], v3 offset:2048
  s_waitcnt vmcnt(25) lgkmcnt(5)
  v_mfma_f32_32x32x16_bf16 v[16:31], v[176:179], v[64:67], 0
  ds_read_b128 v[204:207], v3 offset:30720
  v_mfma_f32_32x32x16_bf16 v[32:47], v[180:183], v[64:67], 0
  ds_read_b128 v[176:179], v6 offset:2048
  s_waitcnt lgkmcnt(5)
  v_mfma_f32_32x32x16_bf16 v[48:63], v[184:187], v[64:67], 0
  s_add_u32 s36, s27, 12288
  buffer_load_dwordx4 v[112:115], v3, s[20:23], s36 offen offset:0 sc1
  ds_read_b128 v[180:183], v3 offset:3072
  s_waitcnt vmcnt(25)
  v_mfma_f32_32x32x16_bf16 v[16:31], v[188:191], v[68:71], v[16:31]
  ds_read_b128 v[184:187], v3 offset:31744
  s_waitcnt lgkmcnt(5)
  v_mfma_f32_32x32x16_bf16 v[32:47], v[192:195], v[68:71], v[32:47]
  ds_read_b128 v[188:191], v6 offset:3072
  v_mfma_f32_32x32x16_bf16 v[48:63], v[196:199], v[68:71], v[48:63]
  buffer_load_dwordx4 v[116:119], v3, s[20:23], s36 offen offset:1024 sc1
  ds_read_b128 v[192:195], v3 offset:4096
  s_waitcnt vmcnt(25) lgkmcnt(5)
  v_mfma_f32_32x32x16_bf16 v[16:31], v[200:203], v[72:75], v[16:31]
  ds_read_b128 v[196:199], v3 offset:32768
  v_mfma_f32_32x32x16_bf16 v[32:47], v[204:207], v[72:75], v[32:47]
  ds_read_b128 v[200:203], v6 offset:4096
  s_waitcnt lgkmcnt(5)
  v_mfma_f32_32x32x16_bf16 v[48:63], v[176:179], v[72:75], v[48:63]
  buffer_load_dwordx4 v[120:123], v3, s[20:23], s36 offen offset:2048 sc1
  ds_read_b128 v[204:207], v3 offset:5120
  s_waitcnt vmcnt(25)
  v_mfma_f32_32x32x16_bf16 v[16:31], v[180:183], v[76:79], v[16:31]
  ds_read_b128 v[176:179], v3 offset:33792
  s_waitcnt lgkmcnt(5)
  v_mfma_f32_32x32x16_bf16 v[32:47], v[184:187], v[76:79], v[32:47]
  ds_read_b128 v[180:183], v6 offset:5120
  v_mfma_f32_32x32x16_bf16 v[48:63], v[188:191], v[76:79], v[48:63]
  buffer_load_dwordx4 v[124:127], v3, s[20:23], s36 offen offset:3072 sc1
  ds_read_b128 v[184:187], v3 offset:6144
  s_waitcnt vmcnt(25) lgkmcnt(5)
  v_mfma_f32_32x32x16_bf16 v[16:31], v[192:195], v[80:83], v[16:31]
  ds_read_b128 v[188:191], v3 offset:34816
  v_mfma_f32_32x32x16_bf16 v[32:47], v[196:199], v[80:83], v[32:47]
  ds_read_b128 v[192:195], v6 offset:6144
  s_waitcnt lgkmcnt(5)
  v_mfma_f32_32x32x16_bf16 v[48:63], v[200:203], v[80:83], v[48:63]
  s_add_u32 s36, s27, 16384
  buffer_load_dwordx4 v[128:131], v3, s[20:23], s36 offen offset:0 sc1
  ds_read_b128 v[196:199], v3 offset:7168
  s_waitcnt vmcnt(25)
  v_mfma_f32_32x32x16_bf16 v[16:31], v[204:207], v[84:87], v[16:31]
  ds_read_b128 v[200:203], v3 offset:35840
  s_waitcnt lgkmcnt(5)
  v_mfma_f32_32x32x16_bf16 v[32:47], v[176:179], v[84:87], v[32:47]
  ds_read_b128 v[204:207], v6 offset:7168
  v_mfma_f32_32x32x16_bf16 v[48:63], v[180:183], v[84:87], v[48:63]
  buffer_load_dwordx4 v[132:135], v3, s[20:23], s36 offen offset:1024 sc1
  ds_read_b128 v[176:179], v3 offset:8192
  s_waitcnt vmcnt(25) lgkmcnt(5)
  v_mfma_f32_32x32x16_bf16 v[16:31], v[184:187], v[88:91], v[16:31]
  ds_read_b128 v[180:183], v3 offset:36864
  v_mfma_f32_32x32x16_bf16 v[32:47], v[188:191], v[88:91], v[32:47]
  ds_read_b128 v[184:187], v6 offset:8192
  s_waitcnt lgkmcnt(5)
  v_mfma_f32_32x32x16_bf16 v[48:63], v[192:195], v[88:91], v[48:63]
  buffer_load_dwordx4 v[136:139], v3, s[20:23], s36 offen offset:2048 sc1
  ds_read_b128 v[188:191], v3 offset:9216
  s_waitcnt vmcnt(25)
  v_mfma_f32_32x32x16_bf16 v[16:31], v[196:199], v[92:95], v[16:31]
  ds_read_b128 v[192:195], v3 offset:37888
  s_waitcnt lgkmcnt(5)
  v_mfma_f32_32x32x16_bf16 v[32:47], v[200:203], v[92:95], v[32:47]
  ds_read_b128 v[196:199], v6 offset:9216
  v_mfma_f32_32x32x16_bf16 v[48:63], v[204:207], v[92:95], v[48:63]
  buffer_load_dwordx4 v[140:143], v3, s[20:23], s36 offen offset:3072 sc1
  ds_read_b128 v[200:203], v3 offset:10240
  s_waitcnt vmcnt(25) lgkmcnt(5)
  v_mfma_f32_32x32x16_bf16 v[16:31], v[176:179], v[96:99], v[16:31]
  ds_read_b128 v[204:207], v3 offset:38912
  v_mfma_f32_32x32x16_bf16 v[32:47], v[180:183], v[96:99], v[32:47]
  ds_read_b128 v[176:179], v6 offset:10240
  s_waitcnt lgkmcnt(5)
  v_mfma_f32_32x32x16_bf16 v[48:63], v[184:187], v[96:99], v[48:63]
  s_add_u32 s36, s27, 20480
  buffer_load_dwordx4 v[144:147], v3, s[20:23], s36 offen offset:0 sc1
  ds_read_b128 v[180:183], v3 offset:11264
  s_waitcnt vmcnt(25)
  v_mfma_f32_32x32x16_bf16 v[16:31], v[188:191], v[100:103], v[16:31]
  ds_read_b128 v[184:187], v3 offset:39936
  s_waitcnt lgkmcnt(5)
  v_mfma_f32_32x32x16_bf16 v[32:47], v[192:195], v[100:103], v[32:47]
  ds_read_b128 v[188:191], v6 offset:11264
  v_mfma_f32_32x32x16_bf16 v[48:63], v[196:199], v[100:103], v[48:63]
  buffer_load_dwordx4 v[148:151], v3, s[20:23], s36 offen offset:1024 sc1
  ds_read_b128 v[192:195], v3 offset:12288
  s_waitcnt vmcnt(25) lgkmcnt(5)
  v_mfma_f32_32x32x16_bf16 v[16:31], v[200:203], v[104:107], v[16:31]
  ds_read_b128 v[196:199], v3 offset:40960
  v_mfma_f32_32x32x16_bf16 v[32:47], v[204:207], v[104:107], v[32:47]
  ds_read_b128 v[200:203], v6 offset:12288
  s_waitcnt lgkmcnt(5)
  v_mfma_f32_32x32x16_bf16 v[48:63], v[176:179], v[104:107], v[48:63]
  buffer_load_dwordx4 v[152:155], v3, s[20:23], s36 offen offset:2048 sc1
  ds_read_b128 v[204:207], v3 offset:13312
  s_waitcnt vmcnt(25)
  v_mfma_f32_32x32x16_bf16 v[16:31], v[180:183], v[108:111], v[16:31]
  ds_read_b128 v[176:179], v3 offset:41984
  s_waitcnt lgkmcnt(5)
  v_mfma_f32_32x32x16_bf16 v[32:47], v[184:187], v[108:111], v[32:47]
  ds_read_b128 v[180:183], v6 offset:13312
  v_mfma_f32_32x32x16_bf16 v[48:63], v[188:191], v[108:111], v[48:63]
  buffer_load_dwordx4 v[156:159], v3, s[20:23], s36 offen offset:3072 sc1
  ds_read_b128 v[184:187], v3 offset:14336
  s_waitcnt vmcnt(11) lgkmcnt(5)
  v_mfma_f32_32x32x16_bf16 v[16:31], v[192:195], v[112:115], v[16:31]
  v_add_f32 v224, v224, v231
  v_add_f32 v225, v225, v232
  v_add_f32 v226, v226, v233
  ds_read_b128 v[188:191], v3 offset:43008
  v_mfma_f32_32x32x16_bf16 v[32:47], v[196:199], v[112:115], v[32:47]
  v_add_f32 v227, v227, v234
  v_add_f32 v228, v228, v235
  v_add_f32 v229, v229, v236
  ds_read_b128 v[192:195], v6 offset:14336
  s_waitcnt lgkmcnt(5)
  v_mfma_f32_32x32x16_bf16 v[48:63], v[200:203], v[112:115], v[48:63]
  s_add_u32 s36, s27, 24576
  buffer_load_dwordx4 v[160:163], v3, s[20:23], s36 offen offset:0 sc1
  ds_read_b128 v[196:199], v3 offset:15360
  s_waitcnt vmcnt(11)
  v_mfma_f32_32x32x16_bf16 v[16:31], v[204:207], v[116:119], v[16:31]
  v_add_f32 v230, v230, v237
  v_add_f32 v224, v224, v227
  v_add_f32 v225, v225, v228
  ds_read_b128 v[200:203], v3 offset:44032
  s_waitcnt lgkmcnt(5)
  v_mfma_f32_32x32x16_bf16 v[32:47], v[176:179], v[116:119], v[32:47]
  v_add_f32 v226, v226, v229
  v_add_f32 v224, v224, v225
  v_add_f32 v226, v226, v230
  ds_read_b128 v[204:207], v6 offset:15360
  v_mfma_f32_32x32x16_bf16 v[48:63], v[180:183], v[116:119], v[48:63]
  buffer_load_dwordx4 v[164:167], v3, s[20:23], s36 offen offset:1024 sc1
  ds_read_b128 v[176:179], v3 offset:16384
  s_waitcnt vmcnt(11) lgkmcnt(5)
  v_mfma_f32_32x32x16_bf16 v[16:31], v[184:187], v[120:123], v[16:31]
  v_add_f32 v8, v224, v226
  v_mov_b32 v10, v8
  s_nop 1
  v_permlane32_swap_b32 v8, v10
  ds_read_b128 v[180:183], v3 offset:45056
  v_mfma_f32_32x32x16_bf16 v[32:47], v[188:191], v[120:123], v[32:47]
  v_mul_f32 v8, 0xbb124925, v8
  v_mul_f32 v10, 0x3b124925, v10
  v_fma_f32 v10, -v8, v8, v10
  ds_read_b128 v[184:187], v6 offset:16384
  s_waitcnt lgkmcnt(5)
  v_mfma_f32_32x32x16_bf16 v[48:63], v[192:195], v[120:123], v[48:63]
  buffer_load_dwordx4 v[168:171], v3, s[20:23], s36 offen offset:2048 sc1
  ds_read_b128 v[188:191], v3 offset:17408
  s_waitcnt vmcnt(11)
  v_mfma_f32_32x32x16_bf16 v[16:31], v[196:199], v[124:127], v[16:31]
  v_cvt_pk_bf16_f32 v216, v8, v8
  v_max_f32 v10, 0, v10
  v_and_b32 v216, s34, v216
  ds_read_b128 v[192:195], v3 offset:46080
  s_waitcnt lgkmcnt(5)
  v_mfma_f32_32x32x16_bf16 v[32:47], v[200:203], v[124:127], v[32:47]
  v_add_f32 v242, 0x3727c5ac, v10
  v_rsq_f32 v11, v242
  v_sub_f32 v217, v8, v216
  ds_read_b128 v[196:199], v6 offset:17408
  v_mfma_f32_32x32x16_bf16 v[48:63], v[204:207], v[124:127], v[48:63]
  buffer_load_dwordx4 v[172:175], v3, s[20:23], s36 offen offset:3072 sc1
  ds_read_b128 v[200:203], v3 offset:18432
  s_waitcnt vmcnt(11) lgkmcnt(5)
  v_mfma_f32_32x32x16_bf16 v[16:31], v[176:179], v[128:131], v[16:31]
  s_add_u32 s80, s76, 0
  buffer_load_dwordx4 a[0:3], v3, s[20:23], s80 offen offset:0
  v_mul_f32 v9, v242, v11
  v_cvt_pk_bf16_f32 v252, v217, v216
  v_cvt_pk_bf16_f32 v218, v9, v9
  ds_read_b128 v[204:207], v3 offset:47104
  v_mfma_f32_32x32x16_bf16 v[32:47], v[180:183], v[128:131], v[32:47]
  buffer_load_dwordx4 a[8:11], v3, s[20:23], s80 offen offset:1024
  v_mov_b32 v253, 0
  v_and_b32 v218, s34, v218
  v_sub_f32 v219, v9, v218
  ds_read_b128 v[176:179], v6 offset:18432
  s_waitcnt lgkmcnt(5)
  v_mfma_f32_32x32x16_bf16 v[48:63], v[184:187], v[128:131], v[48:63]
  ds_read_b128 v[180:183], v3 offset:19456
  s_waitcnt vmcnt(12)
  v_mfma_f32_32x32x16_bf16 v[16:31], v[188:191], v[132:135], v[16:31]
  buffer_load_dwordx4 a[16:19], v3, s[20:23], s80 offen offset:2048
  v_cvt_pk_bf16_f32 v251, v218, v216
  v_cvt_pk_bf16_f32 v250, v218, v219
  v_mul_f32 v240, 0xc0135761, v11
  ds_read_b128 v[184:187], v3 offset:48128
  s_waitcnt lgkmcnt(5)
  v_mfma_f32_32x32x16_bf16 v[32:47], v[192:195], v[132:135], v[32:47]
  buffer_load_dwordx4 a[24:27], v3, s[20:23], s80 offen offset:3072
  v_mul_f32 v241, v11, v11
  v_mul_f32 v241, v241, v11
  v_mul_f32 v241, 0xbdd2d3e8, v241
  ds_read_b128 v[188:191], v6 offset:19456
  v_mfma_f32_32x32x16_bf16 v[48:63], v[196:199], v[132:135], v[48:63]
  ds_read_b128 v[192:195], v3 offset:20480
  s_waitcnt vmcnt(13) lgkmcnt(5)
  v_mfma_f32_32x32x16_bf16 v[16:31], v[200:203], v[136:139], v[16:31]
  s_add_u32 s80, s77, 0
  buffer_load_dwordx4 a[4:7], v3, s[20:23], s80 offen offset:0
  ds_read_b128 v[196:199], v3 offset:49152
  v_mfma_f32_32x32x16_bf16 v[32:47], v[204:207], v[136:139], v[32:47]
  buffer_load_dwordx4 a[12:15], v3, s[20:23], s80 offen offset:1024
  ds_read_b128 v[200:203], v6 offset:20480
  s_waitcnt lgkmcnt(5)
  v_mfma_f32_32x32x16_bf16 v[48:63], v[176:179], v[136:139], v[48:63]
  ds_read_b128 v[204:207], v3 offset:21504
  s_waitcnt vmcnt(14)
  v_mfma_f32_32x32x16_bf16 v[16:31], v[180:183], v[140:143], v[16:31]
  buffer_load_dwordx4 a[20:23], v3, s[20:23], s80 offen offset:2048
  ds_read_b128 v[176:179], v3 offset:50176
  s_waitcnt lgkmcnt(5)
  v_mfma_f32_32x32x16_bf16 v[32:47], v[184:187], v[140:143], v[32:47]
  buffer_load_dwordx4 a[28:31], v3, s[20:23], s80 offen offset:3072
  ds_read_b128 v[180:183], v6 offset:21504
  v_mfma_f32_32x32x16_bf16 v[48:63], v[188:191], v[140:143], v[48:63]
  ds_read_b128 v[184:187], v3 offset:22528
  s_waitcnt vmcnt(15) lgkmcnt(5)
  v_mfma_f32_32x32x16_bf16 v[16:31], v[192:195], v[144:147], v[16:31]
  s_add_u32 s80, s76, 4096
  buffer_load_dwordx4 a[64:67], v3, s[20:23], s80 offen offset:0
  ds_read_b128 v[188:191], v3 offset:51200
  v_mfma_f32_32x32x16_bf16 v[32:47], v[196:199], v[144:147], v[32:47]
  buffer_load_dwordx4 a[72:75], v3, s[20:23], s80 offen offset:1024
  ds_read_b128 v[192:195], v6 offset:22528
  s_waitcnt lgkmcnt(5)
  v_mfma_f32_32x32x16_bf16 v[48:63], v[200:203], v[144:147], v[48:63]
  ds_read_b128 v[196:199], v3 offset:23552
  s_waitcnt vmcnt(16)
  v_mfma_f32_32x32x16_bf16 v[16:31], v[204:207], v[148:151], v[16:31]
  buffer_load_dwordx4 a[80:83], v3, s[20:23], s80 offen offset:2048
  ds_read_b128 v[200:203], v3 offset:52224
  s_waitcnt lgkmcnt(5)
  v_mfma_f32_32x32x16_bf16 v[32:47], v[176:179], v[148:151], v[32:47]
  buffer_load_dwordx4 a[88:91], v3, s[20:23], s80 offen offset:3072
  ds_read_b128 v[204:207], v6 offset:23552
  v_mfma_f32_32x32x16_bf16 v[48:63], v[180:183], v[148:151], v[48:63]
  ds_read_b128 v[176:179], v3 offset:24576
  s_waitcnt vmcnt(17) lgkmcnt(5)
  v_mfma_f32_32x32x16_bf16 v[16:31], v[184:187], v[152:155], v[16:31]
  s_add_u32 s80, s77, 4096
  buffer_load_dwordx4 a[68:71], v3, s[20:23], s80 offen offset:0
  ds_read_b128 v[180:183], v3 offset:53248
  v_mfma_f32_32x32x16_bf16 v[32:47], v[188:191], v[152:155], v[32:47]
  buffer_load_dwordx4 a[76:79], v3, s[20:23], s80 offen offset:1024
  ds_read_b128 v[184:187], v6 offset:24576
  s_waitcnt lgkmcnt(5)
  v_mfma_f32_32x32x16_bf16 v[48:63], v[192:195], v[152:155], v[48:63]
  ds_read_b128 v[188:191], v3 offset:25600
  s_waitcnt vmcnt(18)
  v_mfma_f32_32x32x16_bf16 v[16:31], v[196:199], v[156:159], v[16:31]
  buffer_load_dwordx4 a[84:87], v3, s[20:23], s80 offen offset:2048
  ds_read_b128 v[192:195], v3 offset:54272
  s_waitcnt lgkmcnt(5)
  v_mfma_f32_32x32x16_bf16 v[32:47], v[200:203], v[156:159], v[32:47]
  buffer_load_dwordx4 a[92:95], v3, s[20:23], s80 offen offset:3072
  ds_read_b128 v[196:199], v6 offset:25600
  v_mfma_f32_32x32x16_bf16 v[48:63], v[204:207], v[156:159], v[48:63]
  ds_read_b128 v[200:203], v3 offset:26624
  s_waitcnt vmcnt(19) lgkmcnt(5)
  v_mfma_f32_32x32x16_bf16 v[16:31], v[176:179], v[160:163], v[16:31]
  s_add_u32 s80, s76, 8192
  buffer_load_dwordx4 a[96:99], v3, s[20:23], s80 offen offset:0
  ds_read_b128 v[204:207], v3 offset:55296
  v_mfma_f32_32x32x16_bf16 v[32:47], v[180:183], v[160:163], v[32:47]
  buffer_load_dwordx4 a[104:107], v3, s[20:23], s80 offen offset:1024
  ds_read_b128 v[176:179], v6 offset:26624
  s_waitcnt lgkmcnt(5)
  v_mfma_f32_32x32x16_bf16 v[48:63], v[184:187], v[160:163], v[48:63]
  ds_read_b128 v[180:183], v3 offset:27648
  s_waitcnt vmcnt(20)
  v_mfma_f32_32x32x16_bf16 v[16:31], v[188:191], v[164:167], v[16:31]
  buffer_load_dwordx4 a[112:115], v3, s[20:23], s80 offen offset:2048
  ds_read_b128 v[184:187], v3 offset:56320
  s_waitcnt lgkmcnt(5)
  v_mfma_f32_32x32x16_bf16 v[32:47], v[192:195], v[164:167], v[32:47]
  buffer_load_dwordx4 a[120:123], v3, s[20:23], s80 offen offset:3072
  ds_read_b128 v[188:191], v6 offset:27648
  v_mfma_f32_32x32x16_bf16 v[48:63], v[196:199], v[164:167], v[48:63]
  ds_read_b128 v[192:195], v5 offset:0
  s_waitcnt vmcnt(21) lgkmcnt(5)
  v_mfma_f32_32x32x16_bf16 v[16:31], v[200:203], v[168:171], v[16:31]
  s_add_u32 s80, s77, 8192
  buffer_load_dwordx4 a[100:103], v3, s[20:23], s80 offen offset:0
  ds_read_b128 v[196:199], v5 offset:1024
  v_mfma_f32_32x32x16_bf16 v[32:47], v[204:207], v[168:171], v[32:47]
  buffer_load_dwordx4 a[108:111], v3, s[20:23], s80 offen offset:1024
  ds_read_b128 v[200:203], v5 offset:2048
  s_waitcnt lgkmcnt(5)
  v_mfma_f32_32x32x16_bf16 v[48:63], v[176:179], v[168:171], v[48:63]
  ds_read_b128 v[204:207], v6 offset:28672
  s_waitcnt vmcnt(22)
  v_mfma_f32_32x32x16_bf16 v[16:31], v[180:183], v[172:175], v[16:31]
  buffer_load_dwordx4 a[116:119], v3, s[20:23], s80 offen offset:2048
  ds_read_b128 v[176:179], v6 offset:29696
  s_waitcnt lgkmcnt(5)
  v_mfma_f32_32x32x16_bf16 v[32:47], v[184:187], v[172:175], v[32:47]
  buffer_load_dwordx4 a[124:127], v3, s[20:23], s80 offen offset:3072
  ds_read_b128 v[180:183], v6 offset:30720
  v_mfma_f32_32x32x16_bf16 v[48:63], v[188:191], v[172:175], v[48:63]
  ds_read_b128 v[184:187], v6 offset:31744
  s_waitcnt lgkmcnt(5)
  v_mfma_f32_32x32x16_bf16 v[16:31], v[192:195], v[250:253], v[16:31]
  ds_read_b128 v[188:191], v6 offset:32768
  v_mfma_f32_32x32x16_bf16 v[32:47], v[196:199], v[250:253], v[32:47]
  ds_read_b128 v[192:195], v6 offset:33792
  s_waitcnt lgkmcnt(5)
  v_mfma_f32_32x32x16_bf16 v[48:63], v[200:203], v[250:253], v[48:63]
  ds_read_b128 v[196:199], v6 offset:34816
  v_mfma_f32_32x32x16_bf16 v[224:239], v[204:207], v[64:67], 0
  s_nop 4
  v_mul_f32 v216, v16, v16
  v_fma_f32 v216, v216, v241, v240
  v_mul_f32 v217, v17, v17
  v_mul_f32 v216, v216, v16
  ds_read_b128 v[200:203], v6 offset:35840
  s_waitcnt lgkmcnt(5)
  v_mfma_f32_32x32x16_bf16 v[224:239], v[176:179], v[68:71], v[224:239]
  v_fma_f32 v217, v217, v241, v240
  v_mul_f32 v218, v18, v18
  v_exp_f32 v216, v216
  v_mul_f32 v217, v217, v17
  ds_read_b128 v[204:207], v6 offset:36864
  v_mfma_f32_32x32x16_bf16 v[224:239], v[180:183], v[72:75], v[224:239]
  s_barrier
  v_fma_f32 v218, v218, v241, v240
  v_mul_f32 v219, v19, v19
  v_mul_f32 v24, v16, v24
  v_exp_f32 v217, v217
  ds_read_b128 v[176:179], v6 offset:37888
  s_waitcnt lgkmcnt(5)
  v_mfma_f32_32x32x16_bf16 v[224:239], v[184:187], v[76:79], v[224:239]
  v_mul_f32 v218, v218, v18
  v_fma_f32 v219, v219, v241, v240
  v_mul_f32 v220, v20, v20
  v_fma_f32 v216, v216, v242, v242
  ds_read_b128 v[180:183], v6 offset:38912
  v_mfma_f32_32x32x16_bf16 v[224:239], v[188:191], v[80:83], v[224:239]
  v_mul_f32 v25, v17, v25
  v_exp_f32 v218, v218
  v_mul_f32 v219, v219, v19
  v_fma_f32 v220, v220, v241, v240
  s_add_u32 s64, s58, 0
  s_mov_b32 m0, s64
  s_add_u32 s65, s57, 143360
  buffer_load_dwordx4 v3, s[20:23], s65 offen offset:0 sc1 lds
  ds_read_b128 v[184:187], v6 offset:39936
  s_waitcnt lgkmcnt(5)
  v_mfma_f32_32x32x16_bf16 v[224:239], v[192:195], v[84:87], v[224:239]
  v_mul_f32 v221, v21, v21
  v_rcp_f32 v216, v216
  v_fma_f32 v217, v217, v242, v242
  v_mul_f32 v26, v18, v26
  ds_read_b128 v[188:191], v6 offset:40960
  v_mfma_f32_32x32x16_bf16 v[224:239], v[196:199], v[88:91], v[224:239]
  v_exp_f32 v219, v219
  v_mul_f32 v220, v220, v20
  v_fma_f32 v221, v221, v241, v240
  v_mul_f32 v222, v22, v22
  buffer_load_dwordx4 v3, s[20:23], s65 offen offset:1024 sc1 lds
  ds_read_b128 v[192:195], v6 offset:41984
  s_waitcnt lgkmcnt(5)
  v_mfma_f32_32x32x16_bf16 v[224:239], v[200:203], v[92:95], v[224:239]
  v_mul_f32 v24, v24, v216
  v_rcp_f32 v217, v217
  v_fma_f32 v218, v218, v242, v242
  v_mul_f32 v27, v19, v27
  ds_read_b128 v[196:199], v6 offset:43008
  v_mfma_f32_32x32x16_bf16 v[224:239], v[204:207], v[96:99], v[224:239]
  v_exp_f32 v220, v220
  v_mul_f32 v221, v221, v21
  v_fma_f32 v222, v222, v241, v240
  v_mul_f32 v223, v23, v23
  buffer_load_dwordx4 v3, s[20:23], s65 offen offset:2048 sc1 lds
  ds_read_b128 v[200:203], v6 offset:44032
  s_waitcnt lgkmcnt(5)
  v_mfma_f32_32x32x16_bf16 v[224:239], v[176:179], v[100:103], v[224:239]
  v_mul_f32 v25, v25, v217
  v_rcp_f32 v218, v218
  v_fma_f32 v219, v219, v242, v242
  v_mul_f32 v28, v20, v28
  ds_read_b128 v[204:207], v6 offset:45056
  v_mfma_f32_32x32x16_bf16 v[224:239], v[180:183], v[104:107], v[224:239]
  v_exp_f32 v221, v221
  v_mul_f32 v222, v222, v22
  v_fma_f32 v223, v223, v241, v240
  v_cvt_pk_bf16_f32 v246, v24, v25
  buffer_load_dwordx4 v3, s[20:23], s65 offen offset:3072 sc1 lds
  ds_read_b128 v[176:179], v6 offset:46080
  s_waitcnt lgkmcnt(5)
  v_mfma_f32_32x32x16_bf16 v[224:239], v[184:187], v[108:111], v[224:239]
  v_mul_f32 v26, v26, v218
  v_rcp_f32 v219, v219
  v_fma_f32 v220, v220, v242, v242
  v_mul_f32 v29, v21, v29
  ds_read_b128 v[180:183], v6 offset:47104
  v_mfma_f32_32x32x16_bf16 v[224:239], v[188:191], v[112:115], v[224:239]
  v_exp_f32 v222, v222
  v_mul_f32 v223, v223, v23
  v_mul_f32 v27, v27, v219
  v_rcp_f32 v220, v220
  s_add_u32 s64, s64, 4096
  s_mov_b32 m0, s64
  s_add_u32 s65, s65, 4096
  buffer_load_dwordx4 v3, s[20:23], s65 offen offset:0 sc1 lds
  ds_read_b128 v[184:187], v6 offset:48128
  s_waitcnt lgkmcnt(5)
  v_mfma_f32_32x32x16_bf16 v[224:239], v[192:195], v[116:119], v[224:239]
  v_fma_f32 v221, v221, v242, v242
  v_mul_f32 v30, v22, v30
  v_exp_f32 v223, v223
  v_cvt_pk_bf16_f32 v247, v26, v27
  ds_read_b128 v[188:191], v6 offset:49152
  v_mfma_f32_32x32x16_bf16 v[224:239], v[196:199], v[120:123], v[224:239]
  v_mul_f32 v28, v28, v220
  v_rcp_f32 v221, v221
  v_fma_f32 v222, v222, v242, v242
  v_mul_f32 v31, v23, v31
  buffer_load_dwordx4 v3, s[20:23], s65 offen offset:1024 sc1 lds
  ds_read_b128 v[192:195], v6 offset:50176
  s_waitcnt lgkmcnt(5)
  v_mfma_f32_32x32x16_bf16 v[224:239], v[200:203], v[124:127], v[224:239]
  v_mul_f32 v29, v29, v221
  v_rcp_f32 v222, v222
  v_fma_f32 v223, v223, v242, v242
  v_cvt_pk_bf16_f32 v248, v28, v29
  ds_read_b128 v[196:199], v6 offset:51200
  v_mfma_f32_32x32x16_bf16 v[224:239], v[204:207], v[128:131], v[224:239]
  v_mul_f32 v30, v30, v222
  v_rcp_f32 v223, v223
  s_nop 0
  v_mul_f32 v31, v31, v223
  v_cvt_pk_bf16_f32 v249, v30, v31
  buffer_load_dwordx4 v3, s[20:23], s65 offen offset:2048 sc1 lds
  ds_read_b128 v[200:203], v6 offset:52224
  s_waitcnt lgkmcnt(5)
  v_mfma_f32_32x32x16_bf16 v[224:239], v[176:179], v[132:135], v[224:239]
  buffer_store_dwordx4 v[246:249], v3, s[20:23], s38 offen sc1
  s_add_u32 s38, s38, 1024
  v_mul_f32 v216, v32, v32
  v_fma_f32 v216, v216, v241, v240
  ds_read_b128 v[204:207], v6 offset:53248
  v_mfma_f32_32x32x16_bf16 v[224:239], v[180:183], v[136:139], v[224:239]
  v_mul_f32 v217, v33, v33
  v_mul_f32 v216, v216, v32
  v_fma_f32 v217, v217, v241, v240
  v_mul_f32 v218, v34, v34
  s_add_u32 s64, s58, 28672
  s_mov_b32 m0, s64
  s_add_u32 s65, s57, 172032
  buffer_load_dwordx4 v3, s[20:23], s65 offen offset:0 sc1 lds
  ds_read_b128 v[176:179], v6 offset:54272
  s_waitcnt lgkmcnt(5)
  v_mfma_f32_32x32x16_bf16 v[224:239], v[184:187], v[140:143], v[224:239]
  v_exp_f32 v216, v216
  v_mul_f32 v217, v217, v33
  v_fma_f32 v218, v218, v241, v240
  v_mul_f32 v219, v35, v35
  ds_read_b128 v[180:183], v6 offset:55296
  v_mfma_f32_32x32x16_bf16 v[224:239], v[188:191], v[144:147], v[224:239]
  v_mul_f32 v40, v32, v40
  v_exp_f32 v217, v217
  v_mul_f32 v218, v218, v34
  v_fma_f32 v219, v219, v241, v240
  buffer_load_dwordx4 v3, s[20:23], s65 offen offset:1024 sc1 lds
  ds_read_b128 v[184:187], v6 offset:56320
  s_waitcnt lgkmcnt(5)
  v_mfma_f32_32x32x16_bf16 v[224:239], v[192:195], v[148:151], v[224:239]
  v_mul_f32 v220, v36, v36
  v_fma_f32 v216, v216, v242, v242
  v_mul_f32 v41, v33, v41
  v_exp_f32 v218, v218
  ds_read_b128 v[188:191], v5 offset:3072
  v_mfma_f32_32x32x16_bf16 v[224:239], v[196:199], v[152:155], v[224:239]
  v_mul_f32 v219, v219, v35
  v_fma_f32 v220, v220, v241, v240
  v_mul_f32 v221, v37, v37
  v_rcp_f32 v216, v216
  buffer_load_dwordx4 v3, s[20:23], s65 offen offset:2048 sc1 lds
  ds_read_b128 v[192:195], v4 offset:0
  s_waitcnt lgkmcnt(5)
  v_mfma_f32_32x32x16_bf16 v[224:239], v[200:203], v[156:159], v[224:239]
  v_fma_f32 v217, v217, v242, v242
  v_mul_f32 v42, v34, v42
  v_exp_f32 v219, v219
  v_mul_f32 v220, v220, v36
  ds_read_b128 v[196:199], v4 offset:1024
  v_mfma_f32_32x32x16_bf16 v[224:239], v[204:207], v[160:163], v[224:239]
  v_fma_f32 v221, v221, v241, v240
  v_mul_f32 v222, v38, v38
  v_mul_f32 v40, v40, v216
  v_rcp_f32 v217, v217
  buffer_load_dwordx4 v3, s[20:23], s65 offen offset:3072 sc1 lds
  ds_read_b128 v[200:203], v4 offset:2048
  s_waitcnt lgkmcnt(5)
  v_mfma_f32_32x32x16_bf16 v[224:239], v[176:179], v[164:167], v[224:239]
  v_fma_f32 v218, v218, v242, v242
  v_mul_f32 v43, v35, v43
  v_exp_f32 v220, v220
  v_mul_f32 v221, v221, v37
  ds_read_b128 v[204:207], v4 offset:3072
  v_mfma_f32_32x32x16_bf16 v[224:239], v[180:183], v[168:171], v[224:239]
  v_fma_f32 v222, v222, v241, v240
  v_mul_f32 v223, v39, v39
  v_mul_f32 v41, v41, v217
  v_rcp_f32 v218, v218
  s_add_u32 s64, s64, 4096
  s_mov_b32 m0, s64
  s_add_u32 s65, s65, 4096
  buffer_load_dwordx4 v3, s[20:23], s65 offen offset:0 sc1 lds
  ds_read_b128 v[176:179], v4 offset:4096
  s_waitcnt lgkmcnt(5)
  v_mfma_f32_32x32x16_bf16 v[224:239], v[184:187], v[172:175], v[224:239]
  v_fma_f32 v219, v219, v242, v242
  v_mul_f32 v44, v36, v44
  v_exp_f32 v221, v221
  v_mul_f32 v222, v222, v38
  ds_read_b128 v[180:183], v4 offset:5120
  v_mfma_f32_32x32x16_bf16 v[224:239], v[188:191], v[250:253], v[224:239]
  v_fma_f32 v223, v223, v241, v240
  v_cvt_pk_bf16_f32 v246, v40, v41
  v_mul_f32 v42, v42, v218
  v_rcp_f32 v219, v219
  buffer_load_dwordx4 v3, s[20:23], s65 offen offset:1024 sc1 lds
  ds_read_b128 v[184:187], v4 offset:6144
  s_waitcnt lgkmcnt(5)
  v_mfma_f32_32x32x16_bf16 v[16:31], v[192:195], v[64:67], 0
  v_fma_f32 v220, v220, v242, v242
  v_mul_f32 v45, v37, v45
  v_exp_f32 v222, v222
  v_mul_f32 v223, v223, v39
  buffer_load_dwordx4 v3, s[20:23], s65 offen offset:2048 sc1 lds
  ds_read_b128 v[188:191], v4 offset:7168
  v_mfma_f32_32x32x16_bf16 v[16:31], v[196:199], v[68:71], v[16:31]
  v_mul_f32 v43, v43, v219
  v_rcp_f32 v220, v220
  v_fma_f32 v221, v221, v242, v242
  v_mul_f32 v46, v38, v46
  ds_read_b128 v[192:195], v4 offset:8192
  s_waitcnt lgkmcnt(5)
  v_mfma_f32_32x32x16_bf16 v[16:31], v[200:203], v[72:75], v[16:31]
  v_exp_f32 v223, v223
  v_cvt_pk_bf16_f32 v247, v42, v43
  v_mul_f32 v44, v44, v220
  v_rcp_f32 v221, v221
  s_add_u32 s80, s76, 12288
  buffer_load_dwordx4 a[128:131], v3, s[20:23], s80 offen offset:0
  ds_read_b128 v[196:199], v4 offset:9216
  v_mfma_f32_32x32x16_bf16 v[16:31], v[204:207], v[76:79], v[16:31]
  v_fma_f32 v222, v222, v242, v242
  v_mul_f32 v47, v39, v47
  v_mul_f32 v45, v45, v221
  v_rcp_f32 v222, v222
  ds_read_b128 v[200:203], v4 offset:10240
  s_waitcnt lgkmcnt(5)
  v_mfma_f32_32x32x16_bf16 v[16:31], v[176:179], v[80:83], v[16:31]
  v_fma_f32 v223, v223, v242, v242
  v_cvt_pk_bf16_f32 v248, v44, v45
  v_mul_f32 v46, v46, v222
  v_rcp_f32 v223, v223
  buffer_load_dwordx4 a[136:139], v3, s[20:23], s80 offen offset:1024
  ds_read_b128 v[204:207], v4 offset:11264
  v_mfma_f32_32x32x16_bf16 v[16:31], v[180:183], v[84:87], v[16:31]
  v_mul_f32 v47, v47, v223
  v_cvt_pk_bf16_f32 v249, v46, v47
  buffer_store_dwordx4 v[246:249], v3, s[20:23], s38 offen sc1
  s_add_u32 s38, s38, 1024
  ds_read_b128 v[176:179], v4 offset:12288
  s_waitcnt lgkmcnt(5)
  v_mfma_f32_32x32x16_bf16 v[16:31], v[184:187], v[88:91], v[16:31]
  v_mul_f32 v216, v48, v48
  v_fma_f32 v216, v216, v241, v240
  v_mul_f32 v217, v49, v49
  v_mul_f32 v216, v216, v48
  buffer_load_dwordx4 a[144:147], v3, s[20:23], s80 offen offset:2048
  ds_read_b128 v[180:183], v4 offset:13312
  v_mfma_f32_32x32x16_bf16 v[16:31], v[188:191], v[92:95], v[16:31]
  v_fma_f32 v217, v217, v241, v240
  v_mul_f32 v218, v50, v50
  v_exp_f32 v216, v216
  v_mul_f32 v217, v217, v49
  ds_read_b128 v[184:187], v4 offset:14336
  s_waitcnt lgkmcnt(5)
  v_mfma_f32_32x32x16_bf16 v[16:31], v[192:195], v[96:99], v[16:31]
  v_fma_f32 v218, v218, v241, v240
  v_mul_f32 v219, v51, v51
  v_mul_f32 v56, v48, v56
  v_exp_f32 v217, v217
  buffer_load_dwordx4 a[152:155], v3, s[20:23], s80 offen offset:3072
  ds_read_b128 v[188:191], v4 offset:15360
  v_mfma_f32_32x32x16_bf16 v[16:31], v[196:199], v[100:103], v[16:31]
  v_mul_f32 v218, v218, v50
  v_fma_f32 v219, v219, v241, v240
  v_mul_f32 v220, v52, v52
  v_fma_f32 v216, v216, v242, v242
  ds_read_b128 v[192:195], v4 offset:16384
  s_waitcnt lgkmcnt(5)
  v_mfma_f32_32x32x16_bf16 v[16:31], v[200:203], v[104:107], v[16:31]
  v_mul_f32 v57, v49, v57
  v_exp_f32 v218, v218
  v_mul_f32 v219, v219, v51
  v_fma_f32 v220, v220, v241, v240
  s_add_u32 s80, s77, 12288
  buffer_load_dwordx4 a[132:135], v3, s[20:23], s80 offen offset:0
  ds_read_b128 v[196:199], v4 offset:17408
  v_mfma_f32_32x32x16_bf16 v[16:31], v[204:207], v[108:111], v[16:31]
  v_mul_f32 v221, v53, v53
  v_rcp_f32 v216, v216
  v_fma_f32 v217, v217, v242, v242
  v_mul_f32 v58, v50, v58
  ds_read_b128 v[200:203], v4 offset:18432
  s_waitcnt lgkmcnt(5)
  v_mfma_f32_32x32x16_bf16 v[16:31], v[176:179], v[112:115], v[16:31]
  v_exp_f32 v219, v219
  v_mul_f32 v220, v220, v52
  v_fma_f32 v221, v221, v241, v240
  v_mul_f32 v222, v54, v54
  buffer_load_dwordx4 a[140:143], v3, s[20:23], s80 offen offset:1024
  ds_read_b128 v[204:207], v4 offset:19456
  v_mfma_f32_32x32x16_bf16 v[16:31], v[180:183], v[116:119], v[16:31]
  v_mul_f32 v56, v56, v216
  v_rcp_f32 v217, v217
  v_fma_f32 v218, v218, v242, v242
  v_mul_f32 v59, v51, v59
  ds_read_b128 v[176:179], v4 offset:20480
  s_waitcnt lgkmcnt(5)
  v_mfma_f32_32x32x16_bf16 v[16:31], v[184:187], v[120:123], v[16:31]
  v_exp_f32 v220, v220
  v_mul_f32 v221, v221, v53
  v_fma_f32 v222, v222, v241, v240
  v_mul_f32 v223, v55, v55
  buffer_load_dwordx4 a[148:151], v3, s[20:23], s80 offen offset:2048
  ds_read_b128 v[180:183], v4 offset:21504
  v_mfma_f32_32x32x16_bf16 v[16:31], v[188:191], v[124:127], v[16:31]
  v_mul_f32 v57, v57, v217
  v_rcp_f32 v218, v218
  v_fma_f32 v219, v219, v242, v242
  v_mul_f32 v60, v52, v60
  ds_read_b128 v[184:187], v4 offset:22528
  s_waitcnt lgkmcnt(5)
  v_mfma_f32_32x32x16_bf16 v[16:31], v[192:195], v[128:131], v[16:31]
  v_exp_f32 v221, v221
  v_mul_f32 v222, v222, v54
  v_fma_f32 v223, v223, v241, v240
  v_cvt_pk_bf16_f32 v246, v56, v57
  buffer_load_dwordx4 a[156:159], v3, s[20:23], s80 offen offset:3072
  ds_read_b128 v[188:191], v4 offset:23552
  v_mfma_f32_32x32x16_bf16 v[16:31], v[196:199], v[132:135], v[16:31]
  v_mul_f32 v58, v58, v218
  v_rcp_f32 v219, v219
  v_fma_f32 v220, v220, v242, v242
  v_mul_f32 v61, v53, v61
  ds_read_b128 v[192:195], v4 offset:24576
  s_waitcnt lgkmcnt(5)
  v_mfma_f32_32x32x16_bf16 v[16:31], v[200:203], v[136:139], v[16:31]
  v_exp_f32 v222, v222
  v_mul_f32 v223, v223, v55
  v_mul_f32 v59, v59, v219
  v_rcp_f32 v220, v220
  ds_read_b128 v[196:199], v4 offset:25600
  v_mfma_f32_32x32x16_bf16 v[16:31], v[204:207], v[140:143], v[16:31]
  v_fma_f32 v221, v221, v242, v242
  v_mul_f32 v62, v54, v62
  v_exp_f32 v223, v223
  v_cvt_pk_bf16_f32 v247, v58, v59
  ds_read_b128 v[200:203], v4 offset:26624
  s_waitcnt lgkmcnt(5)
  v_mfma_f32_32x32x16_bf16 v[16:31], v[176:179], v[144:147], v[16:31]
  v_mul_f32 v60, v60, v220
  v_rcp_f32 v221, v221
  v_fma_f32 v222, v222, v242, v242
  v_mul_f32 v63, v55, v63
  ds_read_b128 v[204:207], v4 offset:27648
  v_mfma_f32_32x32x16_bf16 v[16:31], v[180:183], v[148:151], v[16:31]
  s_waitcnt vmcnt(17)
  s_barrier
  v_mul_f32 v61, v61, v221
  v_rcp_f32 v222, v222
  v_fma_f32 v223, v223, v242, v242
  v_cvt_pk_bf16_f32 v248, v60, v61
  ds_read_b128 v[176:179], v5 offset:4096
  s_waitcnt lgkmcnt(5)
  v_mfma_f32_32x32x16_bf16 v[16:31], v[184:187], v[152:155], v[16:31]
  v_mul_f32 v62, v62, v222
  v_rcp_f32 v223, v223
  s_nop 0
  v_mul_f32 v63, v63, v223
  v_cvt_pk_bf16_f32 v249, v62, v63
  ds_read_b128 v[180:183], v3 offset:0
  v_mfma_f32_32x32x16_bf16 v[16:31], v[188:191], v[156:159], v[16:31]
  buffer_store_dwordx4 v[246:249], v3, s[20:23], s38 offen sc1
  s_add_u32 s38, s38, 1024
  v_mul_f32 v216, v224, v224
  v_fma_f32 v216, v216, v241, v240
  ds_read_b128 v[184:187], v3 offset:1024
  s_waitcnt lgkmcnt(5)
  v_mfma_f32_32x32x16_bf16 v[16:31], v[192:195], v[160:163], v[16:31]
  v_mul_f32 v217, v225, v225
  v_mul_f32 v216, v216, v224
  v_fma_f32 v217, v217, v241, v240
  v_mul_f32 v218, v226, v226
  ds_read_b128 v[188:191], v3 offset:2048
  v_mfma_f32_32x32x16_bf16 v[16:31], v[196:199], v[164:167], v[16:31]
  v_exp_f32 v216, v216
  v_mul_f32 v217, v217, v225
  v_fma_f32 v218, v218, v241, v240
  v_mul_f32 v219, v227, v227
  ds_read_b128 v[192:195], v3 offset:3072
  s_waitcnt lgkmcnt(5)
  v_mfma_f32_32x32x16_bf16 v[16:31], v[200:203], v[168:171], v[16:31]
  v_mul_f32 v232, v224, v232
  v_exp_f32 v217, v217
  v_mul_f32 v218, v218, v226
  v_fma_f32 v219, v219, v241, v240
  ds_read_b128 v[196:199], v3 offset:4096
  v_mfma_f32_32x32x16_bf16 v[16:31], v[204:207], v[172:175], v[16:31]
  v_mul_f32 v220, v228, v228
  v_fma_f32 v216, v216, v242, v242
  v_mul_f32 v233, v225, v233
  v_exp_f32 v218, v218
  ds_read_b128 v[200:203], v3 offset:5120
  s_waitcnt lgkmcnt(5)
  v_mfma_f32_32x32x16_bf16 v[16:31], v[176:179], v[250:253], v[16:31]
  v_mul_f32 v219, v219, v227
  v_fma_f32 v220, v220, v241, v240
  v_mul_f32 v221, v229, v229
  v_rcp_f32 v216, v216
  ds_read_b128 v[204:207], v3 offset:6144
  v_mfma_f32_32x32x16_bf16 v[32:47], v[180:183], v[64:67], 0
  v_fma_f32 v217, v217, v242, v242
  v_mul_f32 v234, v226, v234
  v_exp_f32 v219, v219
  v_mul_f32 v220, v220, v228
  ds_read_b128 v[176:179], v3 offset:7168
  s_waitcnt lgkmcnt(5)
  v_mfma_f32_32x32x16_bf16 v[32:47], v[184:187], v[68:71], v[32:47]
  v_fma_f32 v221, v221, v241, v240
  v_mul_f32 v222, v230, v230
  v_mul_f32 v232, v232, v216
  v_rcp_f32 v217, v217
  ds_read_b128 v[180:183], v3 offset:8192
  v_mfma_f32_32x32x16_bf16 v[32:47], v[188:191], v[72:75], v[32:47]
  v_fma_f32 v218, v218, v242, v242
  v_mul_f32 v235, v227, v235
  v_exp_f32 v220, v220
  v_mul_f32 v221, v221, v229
  ds_read_b128 v[184:187], v3 offset:9216
  s_waitcnt lgkmcnt(5)
  v_mfma_f32_32x32x16_bf16 v[32:47], v[192:195], v[76:79], v[32:47]
  v_fma_f32 v222, v222, v241, v240
  v_mul_f32 v223, v231, v231
  v_mul_f32 v233, v233, v217
  v_rcp_f32 v218, v218
  ds_read_b128 v[188:191], v3 offset:10240
  v_mfma_f32_32x32x16_bf16 v[32:47], v[196:199], v[80:83], v[32:47]
  v_fma_f32 v219, v219, v242, v242
  v_mul_f32 v236, v228, v236
  v_exp_f32 v221, v221
  v_mul_f32 v222, v222, v230
  ds_read_b128 v[192:195], v3 offset:11264
  s_waitcnt lgkmcnt(5)
  v_mfma_f32_32x32x16_bf16 v[32:47], v[200:203], v[84:87], v[32:47]
  v_fma_f32 v223, v223, v241, v240
  v_cvt_pk_bf16_f32 v246, v232, v233
  v_mul_f32 v234, v234, v218
  v_rcp_f32 v219, v219
  ds_read_b128 v[196:199], v3 offset:12288
  v_mfma_f32_32x32x16_bf16 v[32:47], v[204:207], v[88:91], v[32:47]
  v_fma_f32 v220, v220, v242, v242
  v_mul_f32 v237, v229, v237
  v_exp_f32 v222, v222
  v_mul_f32 v223, v223, v231
  ds_read_b128 v[200:203], v3 offset:13312
  s_waitcnt lgkmcnt(5)
  v_mfma_f32_32x32x16_bf16 v[32:47], v[176:179], v[92:95], v[32:47]
  v_mul_f32 v235, v235, v219
  v_rcp_f32 v220, v220
  v_fma_f32 v221, v221, v242, v242
  v_mul_f32 v238, v230, v238
  ds_read_b128 v[204:207], v3 offset:14336
  v_mfma_f32_32x32x16_bf16 v[32:47], v[180:183], v[96:99], v[32:47]
  v_exp_f32 v223, v223
  v_cvt_pk_bf16_f32 v247, v234, v235
  v_mul_f32 v236, v236, v220
  v_rcp_f32 v221, v221
  ds_read_b128 v[176:179], v3 offset:15360
  s_waitcnt lgkmcnt(5)
  v_mfma_f32_32x32x16_bf16 v[32:47], v[184:187], v[100:103], v[32:47]
  v_fma_f32 v222, v222, v242, v242
  v_mul_f32 v239, v231, v239
  v_mul_f32 v237, v237, v221
  v_rcp_f32 v222, v222
  ds_read_b128 v[180:183], v3 offset:16384
  v_mfma_f32_32x32x16_bf16 v[32:47], v[188:191], v[104:107], v[32:47]
  v_fma_f32 v223, v223, v242, v242
  v_cvt_pk_bf16_f32 v248, v236, v237
  v_mul_f32 v238, v238, v222
  v_rcp_f32 v223, v223
  ds_read_b128 v[184:187], v3 offset:17408
  s_waitcnt lgkmcnt(5)
  v_mfma_f32_32x32x16_bf16 v[32:47], v[192:195], v[108:111], v[32:47]
  v_mul_f32 v239, v239, v223
  v_cvt_pk_bf16_f32 v249, v238, v239
  buffer_store_dwordx4 v[246:249], v3, s[20:23], s38 offen sc1
  s_add_u32 s38, s38, 1024
  ds_read_b128 v[188:191], v3 offset:18432
  v_mfma_f32_32x32x16_bf16 v[32:47], v[196:199], v[112:115], v[32:47]
  v_mul_f32 v216, v16, v16
  v_fma_f32 v216, v216, v241, v240
  v_mul_f32 v217, v17, v17
  v_mul_f32 v216, v216, v16
  ds_read_b128 v[192:195], v3 offset:19456
  s_waitcnt lgkmcnt(5)
  v_mfma_f32_32x32x16_bf16 v[32:47], v[200:203], v[116:119], v[32:47]
  v_fma_f32 v217, v217, v241, v240
  v_mul_f32 v218, v18, v18
  v_exp_f32 v216, v216
  v_mul_f32 v217, v217, v17
  ds_read_b128 v[196:199], v3 offset:20480
  v_mfma_f32_32x32x16_bf16 v[32:47], v[204:207], v[120:123], v[32:47]
  v_fma_f32 v218, v218, v241, v240
  v_mul_f32 v219, v19, v19
  v_mul_f32 v24, v16, v24
  v_exp_f32 v217, v217
  ds_read_b128 v[200:203], v3 offset:21504
  s_waitcnt lgkmcnt(5)
  v_mfma_f32_32x32x16_bf16 v[32:47], v[176:179], v[124:127], v[32:47]
  v_mul_f32 v218, v218, v18
  v_fma_f32 v219, v219, v241, v240
  v_mul_f32 v220, v20, v20
  v_fma_f32 v216, v216, v242, v242
  ds_read_b128 v[204:207], v3 offset:22528
  v_mfma_f32_32x32x16_bf16 v[32:47], v[180:183], v[128:131], v[32:47]
  v_mul_f32 v25, v17, v25
  v_exp_f32 v218, v218
  v_mul_f32 v219, v219, v19
  v_fma_f32 v220, v220, v241, v240
  ds_read_b128 v[176:179], v3 offset:23552
  s_waitcnt lgkmcnt(5)
  v_mfma_f32_32x32x16_bf16 v[32:47], v[184:187], v[132:135], v[32:47]
  v_mul_f32 v221, v21, v21
  v_rcp_f32 v216, v216
  v_fma_f32 v217, v217, v242, v242
  v_mul_f32 v26, v18, v26
  ds_read_b128 v[180:183], v3 offset:24576
  v_mfma_f32_32x32x16_bf16 v[32:47], v[188:191], v[136:139], v[32:47]
  v_exp_f32 v219, v219
  v_mul_f32 v220, v220, v20
  v_fma_f32 v221, v221, v241, v240
  v_mul_f32 v222, v22, v22
  ds_read_b128 v[184:187], v3 offset:25600
  s_waitcnt lgkmcnt(5)
  v_mfma_f32_32x32x16_bf16 v[32:47], v[192:195], v[140:143], v[32:47]
  v_mul_f32 v24, v24, v216
  v_rcp_f32 v217, v217
  v_fma_f32 v218, v218, v242, v242
  v_mul_f32 v27, v19, v27
  ds_read_b128 v[188:191], v3 offset:26624
  v_mfma_f32_32x32x16_bf16 v[32:47], v[196:199], v[144:147], v[32:47]
  v_exp_f32 v220, v220
  v_mul_f32 v221, v221, v21
  v_fma_f32 v222, v222, v241, v240
  v_mul_f32 v223, v23, v23
  ds_read_b128 v[192:195], v3 offset:27648
  s_waitcnt lgkmcnt(5)
  v_mfma_f32_32x32x16_bf16 v[32:47], v[200:203], v[148:151], v[32:47]
  s_waitcnt vmcnt(11)
  s_barrier
  v_mul_f32 v25, v25, v217
  v_rcp_f32 v218, v218
  v_fma_f32 v219, v219, v242, v242
  v_mul_f32 v28, v20, v28
  ds_read_b128 v[196:199], v5 offset:5120
  v_mfma_f32_32x32x16_bf16 v[32:47], v[204:207], v[152:155], v[32:47]
  v_exp_f32 v221, v221
  v_mul_f32 v222, v222, v22
  v_fma_f32 v223, v223, v241, v240
  v_cvt_pk_bf16_f32 v246, v24, v25
  ds_read_b128 v[200:203], v3 offset:28672
  s_waitcnt lgkmcnt(5)
  v_mfma_f32_32x32x16_bf16 v[32:47], v[176:179], v[156:159], v[32:47]
  v_mul_f32 v26, v26, v218
  v_rcp_f32 v219, v219
  v_fma_f32 v220, v220, v242, v242
  v_mul_f32 v29, v21, v29
  ds_read_b128 v[204:207], v3 offset:29696
  v_mfma_f32_32x32x16_bf16 v[32:47], v[180:183], v[160:163], v[32:47]
  v_exp_f32 v222, v222
  v_mul_f32 v223, v223, v23
  v_mul_f32 v27, v27, v219
  v_rcp_f32 v220, v220
  ds_read_b128 v[176:179], v3 offset:30720
  s_waitcnt lgkmcnt(5)
  v_mfma_f32_32x32x16_bf16 v[32:47], v[184:187], v[164:167], v[32:47]
  v_fma_f32 v221, v221, v242, v242
  v_mul_f32 v30, v22, v30
  v_exp_f32 v223, v223
  v_cvt_pk_bf16_f32 v247, v26, v27
  ds_read_b128 v[180:183], v3 offset:31744
  v_mfma_f32_32x32x16_bf16 v[32:47], v[188:191], v[168:171], v[32:47]
  v_mul_f32 v28, v28, v220
  v_rcp_f32 v221, v221
  v_fma_f32 v222, v222, v242, v242
  v_mul_f32 v31, v23, v31
  ds_read_b128 v[184:187], v3 offset:32768
  s_waitcnt lgkmcnt(5)
  v_mfma_f32_32x32x16_bf16 v[32:47], v[192:195], v[172:175], v[32:47]
  v_mul_f32 v29, v29, v221
  v_rcp_f32 v222, v222
  v_fma_f32 v223, v223, v242, v242
  v_cvt_pk_bf16_f32 v248, v28, v29
  ds_read_b128 v[188:191], v3 offset:33792
  v_mfma_f32_32x32x16_bf16 v[32:47], v[196:199], v[250:253], v[32:47]
  v_mul_f32 v30, v30, v222
  v_rcp_f32 v223, v223
  s_nop 0
  v_mul_f32 v31, v31, v223
  v_cvt_pk_bf16_f32 v249, v30, v31
  ds_read_b128 v[192:195], v3 offset:34816
  s_waitcnt lgkmcnt(5)
  v_mfma_f32_32x32x16_bf16 v[48:63], v[200:203], v[64:67], 0
  buffer_store_dwordx4 v[246:249], v3, s[20:23], s38 offen sc1
  s_add_u32 s38, s38, 1024
  ds_read_b128 v[196:199], v3 offset:35840
  v_mfma_f32_32x32x16_bf16 v[48:63], v[204:207], v[68:71], v[48:63]
  v_mul_f32 v216, v32, v32
  v_fma_f32 v216, v216, v241, v240
  v_mul_f32 v217, v33, v33
  v_mul_f32 v216, v216, v32
  ds_read_b128 v[200:203], v3 offset:36864
  s_waitcnt lgkmcnt(5)
  v_mfma_f32_32x32x16_bf16 v[48:63], v[176:179], v[72:75], v[48:63]
  v_fma_f32 v217, v217, v241, v240
  v_mul_f32 v218, v34, v34
  v_exp_f32 v216, v216
  v_mul_f32 v217, v217, v33
  s_waitcnt vmcnt(1)
  s_mov_b64 exec, 3
  buffer_store_dword v254, v255, s[20:23], s51 offen sc1
  s_mov_b64 exec, -1
  ds_read_b128 v[204:207], v3 offset:37888
  v_mfma_f32_32x32x16_bf16 v[48:63], v[180:183], v[76:79], v[48:63]
  v_fma_f32 v218, v218, v241, v240
  v_mul_f32 v219, v35, v35
  v_mul_f32 v40, v32, v40
  v_exp_f32 v217, v217
  ds_read_b128 v[176:179], v3 offset:38912
  s_waitcnt lgkmcnt(5)
  v_mfma_f32_32x32x16_bf16 v[48:63], v[184:187], v[80:83], v[48:63]
  v_mul_f32 v218, v218, v34
  v_fma_f32 v219, v219, v241, v240
  v_mul_f32 v220, v36, v36
  v_fma_f32 v216, v216, v242, v242
  ds_read_b128 v[180:183], v3 offset:39936
  v_mfma_f32_32x32x16_bf16 v[48:63], v[188:191], v[84:87], v[48:63]
  v_mul_f32 v41, v33, v41
  v_exp_f32 v218, v218
  v_mul_f32 v219, v219, v35
  v_fma_f32 v220, v220, v241, v240
  ds_read_b128 v[184:187], v3 offset:40960
  s_waitcnt lgkmcnt(5)
  v_mfma_f32_32x32x16_bf16 v[48:63], v[192:195], v[88:91], v[48:63]
  v_mul_f32 v221, v37, v37
  v_rcp_f32 v216, v216
  v_fma_f32 v217, v217, v242, v242
  v_mul_f32 v42, v34, v42
  ds_read_b128 v[188:191], v3 offset:41984
  v_mfma_f32_32x32x16_bf16 v[48:63], v[196:199], v[92:95], v[48:63]
  v_exp_f32 v219, v219
  v_mul_f32 v220, v220, v36
  v_fma_f32 v221, v221, v241, v240
  v_mul_f32 v222, v38, v38
  ds_read_b128 v[192:195], v3 offset:43008
  s_waitcnt lgkmcnt(5)
  v_mfma_f32_32x32x16_bf16 v[48:63], v[200:203], v[96:99], v[48:63]
  v_mul_f32 v40, v40, v216
  v_rcp_f32 v217, v217
  v_fma_f32 v218, v218, v242, v242
  v_mul_f32 v43, v35, v43
  ds_read_b128 v[196:199], v3 offset:44032
  v_mfma_f32_32x32x16_bf16 v[48:63], v[204:207], v[100:103], v[48:63]
  v_exp_f32 v220, v220
  v_mul_f32 v221, v221, v37
  v_fma_f32 v222, v222, v241, v240
  v_mul_f32 v223, v39, v39
  ds_read_b128 v[200:203], v3 offset:45056
  s_waitcnt lgkmcnt(5)
  v_mfma_f32_32x32x16_bf16 v[48:63], v[176:179], v[104:107], v[48:63]
  v_mul_f32 v41, v41, v217
  v_rcp_f32 v218, v218
  v_fma_f32 v219, v219, v242, v242
  v_mul_f32 v44, v36, v44
  ds_read_b128 v[204:207], v3 offset:46080
  v_mfma_f32_32x32x16_bf16 v[48:63], v[180:183], v[108:111], v[48:63]
  v_exp_f32 v221, v221
  v_mul_f32 v222, v222, v38
  v_fma_f32 v223, v223, v241, v240
  v_cvt_pk_bf16_f32 v246, v40, v41
  ds_read_b128 v[176:179], v3 offset:47104
  s_waitcnt lgkmcnt(5)
  v_mfma_f32_32x32x16_bf16 v[48:63], v[184:187], v[112:115], v[48:63]
  v_mul_f32 v42, v42, v218
  v_rcp_f32 v219, v219
  v_fma_f32 v220, v220, v242, v242
  v_mul_f32 v45, v37, v45
  ds_read_b128 v[180:183], v3 offset:48128
  v_mfma_f32_32x32x16_bf16 v[48:63], v[188:191], v[116:119], v[48:63]
  v_exp_f32 v222, v222
  v_mul_f32 v223, v223, v39
  v_mul_f32 v43, v43, v219
  v_rcp_f32 v220, v220
  ds_read_b128 v[184:187], v3 offset:49152
  s_waitcnt lgkmcnt(5)
  v_mfma_f32_32x32x16_bf16 v[48:63], v[192:195], v[120:123], v[48:63]
  v_fma_f32 v221, v221, v242, v242
  v_mul_f32 v46, v38, v46
  v_exp_f32 v223, v223
  v_cvt_pk_bf16_f32 v247, v42, v43
  ds_read_b128 v[188:191], v3 offset:50176
  v_mfma_f32_32x32x16_bf16 v[48:63], v[196:199], v[124:127], v[48:63]
  v_mul_f32 v44, v44, v220
  v_rcp_f32 v221, v221
  v_fma_f32 v222, v222, v242, v242
  v_mul_f32 v47, v39, v47
  ds_read_b128 v[192:195], v3 offset:51200
  s_waitcnt lgkmcnt(5)
  v_mfma_f32_32x32x16_bf16 v[48:63], v[200:203], v[128:131], v[48:63]
  v_mul_f32 v45, v45, v221
  v_rcp_f32 v222, v222
  v_fma_f32 v223, v223, v242, v242
  v_cvt_pk_bf16_f32 v248, v44, v45
  ds_read_b128 v[196:199], v3 offset:52224
  v_mfma_f32_32x32x16_bf16 v[48:63], v[204:207], v[132:135], v[48:63]
  v_mul_f32 v46, v46, v222
  v_rcp_f32 v223, v223
  s_nop 0
  v_mul_f32 v47, v47, v223
  v_cvt_pk_bf16_f32 v249, v46, v47
  ds_read_b128 v[200:203], v3 offset:53248
  s_waitcnt lgkmcnt(5)
  v_mfma_f32_32x32x16_bf16 v[48:63], v[176:179], v[136:139], v[48:63]
  buffer_store_dwordx4 v[246:249], v3, s[20:23], s38 offen sc1
  s_add_u32 s38, s38, 1024
  ds_read_b128 v[204:207], v3 offset:54272
  v_mfma_f32_32x32x16_bf16 v[48:63], v[180:183], v[140:143], v[48:63]
  ds_read_b128 v[176:179], v3 offset:55296
  s_waitcnt lgkmcnt(5)
  v_mfma_f32_32x32x16_bf16 v[48:63], v[184:187], v[144:147], v[48:63]
  buffer_load_dword v244, v243, s[20:23], s52 offen sc1
  ds_read_b128 v[180:183], v3 offset:56320
  v_mfma_f32_32x32x16_bf16 v[48:63], v[188:191], v[148:151], v[48:63]
  ds_read_b128 v[184:187], v5 offset:6144
  s_waitcnt lgkmcnt(5)
  v_mfma_f32_32x32x16_bf16 v[48:63], v[192:195], v[152:155], v[48:63]
  v_mfma_f32_32x32x16_bf16 v[48:63], v[196:199], v[156:159], v[48:63]
  s_waitcnt lgkmcnt(3)
  v_mfma_f32_32x32x16_bf16 v[48:63], v[200:203], v[160:163], v[48:63]
  v_mfma_f32_32x32x16_bf16 v[48:63], v[204:207], v[164:167], v[48:63]
  s_waitcnt lgkmcnt(1)
  v_mfma_f32_32x32x16_bf16 v[48:63], v[176:179], v[168:171], v[48:63]
  v_mfma_f32_32x32x16_bf16 v[48:63], v[180:183], v[172:175], v[48:63]
  s_waitcnt lgkmcnt(0)
  v_mfma_f32_32x32x16_bf16 v[48:63], v[184:187], v[250:253], v[48:63]
  s_nop 11
  v_pk_mul_f32 v[216:217], v[48:49], v[48:49]
  v_pk_mul_f32 v[218:219], v[50:51], v[50:51]
  v_pk_mul_f32 v[220:221], v[52:53], v[52:53]
  v_pk_mul_f32 v[222:223], v[54:55], v[54:55]
  v_pk_fma_f32 v[216:217], v[216:217], v[240:241], v[240:241] op_sel:[0,1,0] op_sel_hi:[1,1,0]
  v_pk_fma_f32 v[218:219], v[218:219], v[240:241], v[240:241] op_sel:[0,1,0] op_sel_hi:[1,1,0]
  v_pk_fma_f32 v[220:221], v[220:221], v[240:241], v[240:241] op_sel:[0,1,0] op_sel_hi:[1,1,0]
  v_pk_fma_f32 v[222:223], v[222:223], v[240:241], v[240:241] op_sel:[0,1,0] op_sel_hi:[1,1,0]
  v_pk_mul_f32 v[216:217], v[216:217], v[48:49]
  v_pk_mul_f32 v[218:219], v[218:219], v[50:51]
  v_pk_mul_f32 v[220:221], v[220:221], v[52:53]
  v_pk_mul_f32 v[222:223], v[222:223], v[54:55]
  v_exp_f32 v216, v216
  v_exp_f32 v218, v218
  v_exp_f32 v220, v220
  v_exp_f32 v222, v222
  v_exp_f32 v217, v217
  v_exp_f32 v219, v219
  v_exp_f32 v221, v221
  v_exp_f32 v223, v223
  v_pk_mul_f32 v[56:57], v[48:49], v[56:57]
  v_pk_mul_f32 v[58:59], v[50:51], v[58:59]
  v_pk_mul_f32 v[60:61], v[52:53], v[60:61]
  v_pk_mul_f32 v[62:63], v[54:55], v[62:63]
  v_pk_fma_f32 v[216:217], v[216:217], v[242:243], v[242:243] op_sel_hi:[1,0,0]
  v_pk_fma_f32 v[218:219], v[218:219], v[242:243], v[242:243] op_sel_hi:[1,0,0]
  v_pk_fma_f32 v[220:221], v[220:221], v[242:243], v[242:243] op_sel_hi:[1,0,0]
  v_pk_fma_f32 v[222:223], v[222:223], v[242:243], v[242:243] op_sel_hi:[1,0,0]
  v_rcp_f32 v216, v216
  v_rcp_f32 v218, v218
  v_rcp_f32 v220, v220
  v_rcp_f32 v222, v222
  v_rcp_f32 v217, v217
  v_rcp_f32 v219, v219
  v_rcp_f32 v221, v221
  v_rcp_f32 v223, v223
  v_pk_mul_f32 v[56:57], v[56:57], v[216:217]
  v_pk_mul_f32 v[58:59], v[58:59], v[218:219]
  v_pk_mul_f32 v[60:61], v[60:61], v[220:221]
  v_pk_mul_f32 v[62:63], v[62:63], v[222:223]
  v_cvt_pk_bf16_f32 v246, v56, v57
  v_cvt_pk_bf16_f32 v247, v58, v59
  v_cvt_pk_bf16_f32 v248, v60, v61
  v_cvt_pk_bf16_f32 v249, v62, v63
  buffer_store_dwordx4 v[246:249], v3, s[20:23], s38 offen sc1
  s_mul_i32 s29, s44, 28672
  s_lshl_b32 s36, s46, 11
  s_add_u32 s29, s29, s36
  s_add_u32 s29, s29, 12115968
  s_lshl_b32 s36, s46, 7
  s_add_u32 s36, s36, 3265792
  v_lshlrev_b32 v6, 4, v7
  s_xor_b32 s40, s24, 1
  s_mul_i32 s40, s40, 3
  s_add_u32 s40, s40, 0
  s_lshl_b32 s40, s40, 12
  s_add_u32 s40, s40, 114688
  s_xor_b32 s41, s24, 2
  s_mul_i32 s41, s41, 3
  s_add_u32 s41, s41, 1
  s_lshl_b32 s41, s41, 12
  s_add_u32 s41, s41, 114688
  s_xor_b32 s42, s24, 3
  s_mul_i32 s42, s42, 3
  s_add_u32 s42, s42, 2
  s_lshl_b32 s42, s42, 12
  s_add_u32 s42, s42, 114688
  s_waitcnt vmcnt(0)
  s_mov_b64 exec, 3
  buffer_store_dword v254, v255, s[20:23], s30 offen sc1
  s_mov_b64 exec, -1
  s_cmp_ge_u32 s61, 28
  s_cbranch_scc1 M_end
  v_cmp_ne_u32 vcc, v254, v244
  s_nop 0
  s_cmp_eq_u64 vcc, 0
  s_cbranch_scc1 Lsp14x
  s_mov_b32 s66, 0
Lsp14:
  buffer_load_dword v244, v243, s[20:23], s52 offen sc1
  s_add_u32 s66, s66, 1
  s_waitcnt vmcnt(0)
  v_cmp_ne_u32 vcc, v254, v244
  s_cmp_gt_u32 s66, 400000
  s_cbranch_scc1 Lsp14x
  s_cmp_lg_u64 vcc, 0
  s_cbranch_scc1 Lsp14
Lsp14x:
  s_add_u32 s37, s48, 0
  buffer_load_dwordx4 v[80:83], v3, s[20:23], s37 offen offset:0 sc1
  s_add_u32 s37, s49, 0
  buffer_load_dwordx4 v[84:87], v3, s[20:23], s37 offen offset:0 sc1
  s_add_u32 s37, s48, 4096
  buffer_load_dwordx4 v[88:91], v3, s[20:23], s37 offen offset:3072 sc1
  s_add_u32 s37, s49, 4096
  buffer_load_dwordx4 v[92:95], v3, s[20:23], s37 offen offset:3072 sc1
  s_add_u32 s37, s48, 12288
  buffer_load_dwordx4 v[96:99], v3, s[20:23], s37 offen offset:2048 sc1
  s_add_u32 s37, s49, 12288
  buffer_load_dwordx4 v[100:103], v3, s[20:23], s37 offen offset:2048 sc1
  s_add_u32 s37, s48, 20480
  buffer_load_dwordx4 v[104:107], v3, s[20:23], s37 offen offset:1024 sc1
  s_add_u32 s37, s49, 20480
  buffer_load_dwordx4 v[108:111], v3, s[20:23], s37 offen offset:1024 sc1
  s_add_u32 s37, s48, 0
  buffer_load_dwordx4 v[112:115], v3, s[20:23], s37 offen offset:1024 sc1
  s_add_u32 s37, s49, 0
  buffer_load_dwordx4 v[116:119], v3, s[20:23], s37 offen offset:1024 sc1
  buffer_load_dwordx4 v[224:227], v3, s[20:23], s29 offen sc1
  buffer_load_dwordx4 v[228:231], v3, s[20:23], s29 offen offset:1024 sc1
  s_barrier
  s_waitcnt vmcnt(10)
  v_mfma_f32_32x32x16_bf16 v[64:79], a[4:7], v[84:87], 0
  v_mfma_f32_32x32x16_bf16 v[48:63], a[0:3], v[84:87], 0
  s_add_u32 s37, s48, 8192
  buffer_load_dwordx4 v[120:123], v3, s[20:23], s37 offen offset:0 sc1
  s_add_u32 s37, s49, 8192
  buffer_load_dwordx4 v[124:127], v3, s[20:23], s37 offen offset:0 sc1
  v_mfma_f32_32x32x16_bf16 v[32:47], a[4:7], v[80:83], 0
  v_mfma_f32_32x32x16_bf16 v[16:31], a[0:3], v[80:83], 0
  s_waitcnt vmcnt(10)
  v_mfma_f32_32x32x16_bf16 v[64:79], a[92:95], v[92:95], v[64:79]
  v_mfma_f32_32x32x16_bf16 v[48:63], a[88:91], v[92:95], v[48:63]
  s_add_u32 s37, s48, 12288
  buffer_load_dwordx4 v[128:131], v3, s[20:23], s37 offen offset:3072 sc1
  s_add_u32 s37, s49, 12288
  buffer_load_dwordx4 v[132:135], v3, s[20:23], s37 offen offset:3072 sc1
  v_mfma_f32_32x32x16_bf16 v[32:47], a[92:95], v[88:91], v[32:47]
  v_mfma_f32_32x32x16_bf16 v[16:31], a[88:91], v[88:91], v[16:31]
  s_waitcnt vmcnt(10)
  v_mfma_f32_32x32x16_bf16 v[64:79], a[148:151], v[100:103], v[64:79]
  v_mfma_f32_32x32x16_bf16 v[48:63], a[144:147], v[100:103], v[48:63]
  s_add_u32 s37, s48, 20480
  buffer_load_dwordx4 v[136:139], v3, s[20:23], s37 offen offset:2048 sc1
  s_add_u32 s37, s49, 20480
  buffer_load_dwordx4 v[140:143], v3, s[20:23], s37 offen offset:2048 sc1
  v_mfma_f32_32x32x16_bf16 v[32:47], a[148:151], v[96:99], v[32:47]
  v_mfma_f32_32x32x16_bf16 v[16:31], a[144:147], v[96:99], v[16:31]
  s_waitcnt vmcnt(10)
  v_mfma_f32_32x32x16_bf16 v[64:79], a[204:207], v[108:111], v[64:79]
  v_mfma_f32_32x32x16_bf16 v[48:63], a[200:203], v[108:111], v[48:63]
  s_add_u32 s37, s48, 0
  buffer_load_dwordx4 v[144:147], v3, s[20:23], s37 offen offset:2048 sc1
  s_add_u32 s37, s49, 0
  buffer_load_dwordx4 v[148:151], v3, s[20:23], s37 offen offset:2048 sc1
  v_mfma_f32_32x32x16_bf16 v[32:47], a[204:207], v[104:107], v[32:47]
  v_mfma_f32_32x32x16_bf16 v[16:31], a[200:203], v[104:107], v[16:31]
  s_waitcnt vmcnt(10)
  v_mfma_f32_32x32x16_bf16 v[64:79], a[12:15], v[116:119], v[64:79]
  v_mfma_f32_32x32x16_bf16 v[48:63], a[8:11], v[116:119], v[48:63]
  s_add_u32 s37, s48, 8192
  buffer_load_dwordx4 v[152:155], v3, s[20:23], s37 offen offset:1024 sc1
  s_add_u32 s37, s49, 8192
  buffer_load_dwordx4 v[156:159], v3, s[20:23], s37 offen offset:1024 sc1
  v_mfma_f32_32x32x16_bf16 v[32:47], a[12:15], v[112:115], v[32:47]
  v_mfma_f32_32x32x16_bf16 v[16:31], a[8:11], v[112:115], v[16:31]
  s_waitcnt vmcnt(8)
  v_mfma_f32_32x32x16_bf16 v[64:79], a[100:103], v[124:127], v[64:79]
  v_mfma_f32_32x32x16_bf16 v[48:63], a[96:99], v[124:127], v[48:63]
  s_add_u32 s37, s48, 16384
  buffer_load_dwordx4 v[160:163], v3, s[20:23], s37 offen offset:0 sc1
  s_add_u32 s37, s49, 16384
  buffer_load_dwordx4 v[164:167], v3, s[20:23], s37 offen offset:0 sc1
  v_mfma_f32_32x32x16_bf16 v[32:47], a[100:103], v[120:123], v[32:47]
  v_mfma_f32_32x32x16_bf16 v[16:31], a[96:99], v[120:123], v[16:31]
  s_waitcnt vmcnt(8)
  v_mfma_f32_32x32x16_bf16 v[64:79], a[156:159], v[132:135], v[64:79]
  v_mfma_f32_32x32x16_bf16 v[48:63], a[152:155], v[132:135], v[48:63]
  s_add_u32 s37, s48, 20480
  buffer_load_dwordx4 v[168:171], v3, s[20:23], s37 offen offset:3072 sc1
  s_add_u32 s37, s49, 20480
  buffer_load_dwordx4 v[172:175], v3, s[20:23], s37 offen offset:3072 sc1
  v_mfma_f32_32x32x16_bf16 v[32:47], a[156:159], v[128:131], v[32:47]
  v_mfma_f32_32x32x16_bf16 v[16:31], a[152:155], v[128:131], v[16:31]
  s_waitcnt vmcnt(8)
  v_mfma_f32_32x32x16_bf16 v[64:79], a[212:215], v[140:143], v[64:79]
  v_mfma_f32_32x32x16_bf16 v[48:63], a[208:211], v[140:143], v[48:63]
  s_add_u32 s37, s48, 0
  buffer_load_dwordx4 v[176:179], v3, s[20:23], s37 offen offset:3072 sc1
  s_add_u32 s37, s49, 0
  buffer_load_dwordx4 v[180:183], v3, s[20:23], s37 offen offset:3072 sc1
  v_mfma_f32_32x32x16_bf16 v[32:47], a[212:215], v[136:139], v[32:47]
  v_mfma_f32_32x32x16_bf16 v[16:31], a[208:211], v[136:139], v[16:31]
  s_waitcnt vmcnt(8)
  buffer_load_dword v245, v243, s[20:23], s54 offen sc1
  v_mfma_f32_32x32x16_bf16 v[64:79], a[20:23], v[148:151], v[64:79]
  v_mfma_f32_32x32x16_bf16 v[48:63], a[16:19], v[148:151], v[48:63]
  s_add_u32 s37, s48, 8192
  buffer_load_dwordx4 v[184:187], v3, s[20:23], s37 offen offset:2048 sc1
  s_add_u32 s37, s49, 8192
  buffer_load_dwordx4 v[188:191], v3, s[20:23], s37 offen offset:2048 sc1
  v_mfma_f32_32x32x16_bf16 v[32:47], a[20:23], v[144:147], v[32:47]
  v_mfma_f32_32x32x16_bf16 v[16:31], a[16:19], v[144:147], v[16:31]
  s_waitcnt vmcnt(9)
  v_mfma_f32_32x32x16_bf16 v[64:79], a[108:111], v[156:159], v[64:79]
  v_mfma_f32_32x32x16_bf16 v[48:63], a[104:107], v[156:159], v[48:63]
  s_add_u32 s37, s48, 16384
  buffer_load_dwordx4 v[192:195], v3, s[20:23], s37 offen offset:1024 sc1
  s_add_u32 s37, s49, 16384
  buffer_load_dwordx4 v[196:199], v3, s[20:23], s37 offen offset:1024 sc1
  v_mfma_f32_32x32x16_bf16 v[32:47], a[108:111], v[152:155], v[32:47]
  v_mfma_f32_32x32x16_bf16 v[16:31], a[104:107], v[152:155], v[16:31]
  s_waitcnt vmcnt(9)
  v_mfma_f32_32x32x16_bf16 v[64:79], a[164:167], v[164:167], v[64:79]
  v_mfma_f32_32x32x16_bf16 v[48:63], a[160:163], v[164:167], v[48:63]
  s_add_u32 s37, s48, 24576
  buffer_load_dwordx4 v[200:203], v3, s[20:23], s37 offen offset:0 sc1
  s_add_u32 s37, s49, 24576
  buffer_load_dwordx4 v[204:207], v3, s[20:23], s37 offen offset:0 sc1
  v_mfma_f32_32x32x16_bf16 v[32:47], a[164:167], v[160:163], v[32:47]
  v_mfma_f32_32x32x16_bf16 v[16:31], a[160:163], v[160:163], v[16:31]
  s_waitcnt vmcnt(9)
  s_waitcnt vmcnt(6)
  v_cmp_ne_u32 vcc, v254, v245
  s_nop 0
  s_cmp_eq_u64 vcc, 0
  s_cbranch_scc1 Lsp15x
  s_mov_b32 s66, 0
Lsp15:
  buffer_load_dword v245, v243, s[20:23], s54 offen sc1
  s_add_u32 s66, s66, 1
  s_waitcnt vmcnt(0)
  v_cmp_ne_u32 vcc, v254, v245
  s_cmp_gt_u32 s66, 400000
  s_cbranch_scc1 Lsp15x
  s_cmp_lg_u64 vcc, 0
  s_cbranch_scc1 Lsp15
Lsp15x:
  v_mfma_f32_32x32x16_bf16 v[64:79], a[220:223], v[172:175], v[64:79]
  v_mfma_f32_32x32x16_bf16 v[48:63], a[216:219], v[172:175], v[48:63]
  s_add_u32 s37, s48, 4096
  buffer_load_dwordx4 v[80:83], v3, s[20:23], s37 offen offset:0 sc1
  s_add_u32 s37, s49, 4096
  buffer_load_dwordx4 v[84:87], v3, s[20:23], s37 offen offset:0 sc1
  v_mfma_f32_32x32x16_bf16 v[32:47], a[220:223], v[168:171], v[32:47]
  v_mfma_f32_32x32x16_bf16 v[16:31], a[216:219], v[168:171], v[16:31]
  s_waitcnt vmcnt(9)
  v_mfma_f32_32x32x16_bf16 v[64:79], a[28:31], v[180:183], v[64:79]
  v_mfma_f32_32x32x16_bf16 v[48:63], a[24:27], v[180:183], v[48:63]
  s_add_u32 s37, s48, 8192
  buffer_load_dwordx4 v[88:91], v3, s[20:23], s37 offen offset:3072 sc1
  s_add_u32 s37, s49, 8192
  buffer_load_dwordx4 v[92:95], v3, s[20:23], s37 offen offset:3072 sc1
  v_mfma_f32_32x32x16_bf16 v[32:47], a[28:31], v[176:179], v[32:47]
  v_mfma_f32_32x32x16_bf16 v[16:31], a[24:27], v[176:179], v[16:31]
  v_lshlrev_b32 v208, 16, v224
  v_and_b32 v209, s34, v224
  s_waitcnt vmcnt(8)
  v_mfma_f32_32x32x16_bf16 v[64:79], a[116:119], v[188:191], v[64:79]
  v_mfma_f32_32x32x16_bf16 v[48:63], a[112:115], v[188:191], v[48:63]
  s_add_u32 s37, s48, 16384
  buffer_load_dwordx4 v[96:99], v3, s[20:23], s37 offen offset:2048 sc1
  s_add_u32 s37, s49, 16384
  buffer_load_dwordx4 v[100:103], v3, s[20:23], s37 offen offset:2048 sc1
  v_mfma_f32_32x32x16_bf16 v[32:47], a[116:119], v[184:187], v[32:47]
  v_mfma_f32_32x32x16_bf16 v[16:31], a[112:115], v[184:187], v[16:31]
  v_lshlrev_b32 v210, 16, v225
  v_and_b32 v211, s34, v225
  s_waitcnt vmcnt(8)
  v_mfma_f32_32x32x16_bf16 v[64:79], a[172:175], v[196:199], v[64:79]
  v_mfma_f32_32x32x16_bf16 v[48:63], a[168:171], v[196:199], v[48:63]
  s_add_u32 s37, s48, 24576
  buffer_load_dwordx4 v[104:107], v3, s[20:23], s37 offen offset:1024 sc1
  s_add_u32 s37, s49, 24576
  buffer_load_dwordx4 v[108:111], v3, s[20:23], s37 offen offset:1024 sc1
  v_mfma_f32_32x32x16_bf16 v[32:47], a[172:175], v[192:195], v[32:47]
  v_mfma_f32_32x32x16_bf16 v[16:31], a[168:171], v[192:195], v[16:31]
  v_lshlrev_b32 v212, 16, v226
  v_and_b32 v213, s34, v226
  s_waitcnt vmcnt(8)
  v_mfma_f32_32x32x16_bf16 v[64:79], a[228:231], v[204:207], v[64:79]
  v_mfma_f32_32x32x16_bf16 v[48:63], a[224:227], v[204:207], v[48:63]
  s_add_u32 s37, s48, 4096
  buffer_load_dwordx4 v[112:115], v3, s[20:23], s37 offen offset:1024 sc1
  s_add_u32 s37, s49, 4096
  buffer_load_dwordx4 v[116:119], v3, s[20:23], s37 offen offset:1024 sc1
  v_mfma_f32_32x32x16_bf16 v[32:47], a[228:231], v[200:203], v[32:47]
  v_mfma_f32_32x32x16_bf16 v[16:31], a[224:227], v[200:203], v[16:31]
  v_lshlrev_b32 v214, 16, v227
  v_and_b32 v215, s34, v227
  s_waitcnt vmcnt(8)
  v_mfma_f32_32x32x16_bf16 v[64:79], a[68:71], v[84:87], v[64:79]
  v_mfma_f32_32x32x16_bf16 v[48:63], a[64:67], v[84:87], v[48:63]
  s_add_u32 s37, s48, 12288
  buffer_load_dwordx4 v[120:123], v3, s[20:23], s37 offen offset:0 sc1
  s_add_u32 s37, s49, 12288
  buffer_load_dwordx4 v[124:127], v3, s[20:23], s37 offen offset:0 sc1
  v_mfma_f32_32x32x16_bf16 v[32:47], a[68:71], v[80:83], v[32:47]
  v_mfma_f32_32x32x16_bf16 v[16:31], a[64:67], v[80:83], v[16:31]
  v_lshlrev_b32 v216, 16, v228
  v_and_b32 v217, s34, v228
  s_waitcnt vmcnt(8)
  v_mfma_f32_32x32x16_bf16 v[64:79], a[124:127], v[92:95], v[64:79]
  v_mfma_f32_32x32x16_bf16 v[48:63], a[120:123], v[92:95], v[48:63]
  s_add_u32 s37, s48, 16384
  buffer_load_dwordx4 v[128:131], v3, s[20:23], s37 offen offset:3072 sc1
  s_add_u32 s37, s49, 16384
  buffer_load_dwordx4 v[132:135], v3, s[20:23], s37 offen offset:3072 sc1
  v_mfma_f32_32x32x16_bf16 v[32:47], a[124:127], v[88:91], v[32:47]
  v_mfma_f32_32x32x16_bf16 v[16:31], a[120:123], v[88:91], v[16:31]
  v_lshlrev_b32 v218, 16, v229
  v_and_b32 v219, s34, v229
  s_waitcnt vmcnt(8)
  v_mfma_f32_32x32x16_bf16 v[64:79], a[180:183], v[100:103], v[64:79]
  v_mfma_f32_32x32x16_bf16 v[48:63], a[176:179], v[100:103], v[48:63]
  s_add_u32 s37, s48, 24576
  buffer_load_dwordx4 v[136:139], v3, s[20:23], s37 offen offset:2048 sc1
  s_add_u32 s37, s49, 24576
  buffer_load_dwordx4 v[140:143], v3, s[20:23], s37 offen offset:2048 sc1
  v_mfma_f32_32x32x16_bf16 v[32:47], a[180:183], v[96:99], v[32:47]
  v_mfma_f32_32x32x16_bf16 v[16:31], a[176:179], v[96:99], v[16:31]
  v_lshlrev_b32 v220, 16, v230
  v_and_b32 v221, s34, v230
  buffer_load_dwordx4 v[176:179], v6, s[20:23], s36 offen offset:0
  buffer_load_dwordx4 v[180:183], v6, s[20:23], s36 offen offset:32
  buffer_load_dwordx4 v[184:187], v6, s[20:23], s36 offen offset:64
  buffer_load_dwordx4 v[188:191], v6, s[20:23], s36 offen offset:96
  s_waitcnt vmcnt(12)
  v_mfma_f32_32x32x16_bf16 v[64:79], a[236:239], v[108:111], v[64:79]
  v_mfma_f32_32x32x16_bf16 v[48:63], a[232:235], v[108:111], v[48:63]
  s_add_u32 s37, s48, 4096
  buffer_load_dwordx4 v[144:147], v3, s[20:23], s37 offen offset:2048 sc1
  s_add_u32 s37, s49, 4096
  buffer_load_dwordx4 v[148:151], v3, s[20:23], s37 offen offset:2048 sc1
  v_mfma_f32_32x32x16_bf16 v[32:47], a[236:239], v[104:107], v[32:47]
  v_mfma_f32_32x32x16_bf16 v[16:31], a[232:235], v[104:107], v[16:31]
  v_lshlrev_b32 v222, 16, v231
  v_and_b32 v223, s34, v231
  s_waitcnt vmcnt(12)
  v_mfma_f32_32x32x16_bf16 v[64:79], a[76:79], v[116:119], v[64:79]
  v_mfma_f32_32x32x16_bf16 v[48:63], a[72:75], v[116:119], v[48:63]
  s_add_u32 s37, s48, 12288
  buffer_load_dwordx4 v[152:155], v3, s[20:23], s37 offen offset:1024 sc1
  s_add_u32 s37, s49, 12288
  buffer_load_dwordx4 v[156:159], v3, s[20:23], s37 offen offset:1024 sc1
  v_mfma_f32_32x32x16_bf16 v[32:47], a[76:79], v[112:115], v[32:47]
  v_mfma_f32_32x32x16_bf16 v[16:31], a[72:75], v[112:115], v[16:31]
  s_waitcnt vmcnt(12)
  v_mfma_f32_32x32x16_bf16 v[64:79], a[132:135], v[124:127], v[64:79]
  v_mfma_f32_32x32x16_bf16 v[48:63], a[128:131], v[124:127], v[48:63]
  s_add_u32 s37, s48, 20480
  buffer_load_dwordx4 v[160:163], v3, s[20:23], s37 offen offset:0 sc1
  s_add_u32 s37, s49, 20480
  buffer_load_dwordx4 v[164:167], v3, s[20:23], s37 offen offset:0 sc1
  v_mfma_f32_32x32x16_bf16 v[32:47], a[132:135], v[120:123], v[32:47]
  v_mfma_f32_32x32x16_bf16 v[16:31], a[128:131], v[120:123], v[16:31]
  s_waitcnt vmcnt(12)
  v_mfma_f32_32x32x16_bf16 v[64:79], a[188:191], v[132:135], v[64:79]
  v_mfma_f32_32x32x16_bf16 v[48:63], a[184:187], v[132:135], v[48:63]
  s_add_u32 s37, s48, 24576
  buffer_load_dwordx4 v[168:171], v3, s[20:23], s37 offen offset:3072 sc1
  s_add_u32 s37, s49, 24576
  buffer_load_dwordx4 v[172:175], v3, s[20:23], s37 offen offset:3072 sc1
  v_mfma_f32_32x32x16_bf16 v[32:47], a[188:191], v[128:131], v[32:47]
  v_mfma_f32_32x32x16_bf16 v[16:31], a[184:187], v[128:131], v[16:31]
  s_waitcnt vmcnt(12)
  v_mfma_f32_32x32x16_bf16 v[64:79], a[244:247], v[140:143], v[64:79]
  v_mfma_f32_32x32x16_bf16 v[48:63], a[240:243], v[140:143], v[48:63]
  v_mfma_f32_32x32x16_bf16 v[32:47], a[244:247], v[136:139], v[32:47]
  v_mfma_f32_32x32x16_bf16 v[16:31], a[240:243], v[136:139], v[16:31]
  s_waitcnt vmcnt(6)
  v_mfma_f32_32x32x16_bf16 v[64:79], a[84:87], v[148:151], v[64:79]
  v_mfma_f32_32x32x16_bf16 v[48:63], a[80:83], v[148:151], v[48:63]
  v_mfma_f32_32x32x16_bf16 v[32:47], a[84:87], v[144:147], v[32:47]
  v_mfma_f32_32x32x16_bf16 v[16:31], a[80:83], v[144:147], v[16:31]
  s_waitcnt vmcnt(4)
  v_mfma_f32_32x32x16_bf16 v[64:79], a[140:143], v[156:159], v[64:79]
  v_mfma_f32_32x32x16_bf16 v[48:63], a[136:139], v[156:159], v[48:63]
  v_mfma_f32_32x32x16_bf16 v[32:47], a[140:143], v[152:155], v[32:47]
  v_mfma_f32_32x32x16_bf16 v[16:31], a[136:139], v[152:155], v[16:31]
  s_waitcnt vmcnt(2)
  v_mfma_f32_32x32x16_bf16 v[64:79], a[196:199], v[164:167], v[64:79]
  v_mfma_f32_32x32x16_bf16 v[48:63], a[192:195], v[164:167], v[48:63]
  v_mfma_f32_32x32x16_bf16 v[32:47], a[196:199], v[160:163], v[32:47]
  v_mfma_f32_32x32x16_bf16 v[16:31], a[192:195], v[160:163], v[16:31]
  s_waitcnt vmcnt(0)
  v_mfma_f32_32x32x16_bf16 v[64:79], a[252:255], v[172:175], v[64:79]
  v_mfma_f32_32x32x16_bf16 v[48:63], a[248:251], v[172:175], v[48:63]
  v_mfma_f32_32x32x16_bf16 v[32:47], a[252:255], v[168:171], v[32:47]
  v_mfma_f32_32x32x16_bf16 v[16:31], a[248:251], v[168:171], v[16:31]
  s_waitcnt vmcnt(8)
  v_add_u32 v4, s42, v3
  s_nop 6
  ds_write_b128 v4, v[64:67] offset:0
  ds_write_b128 v4, v[68:71] offset:1024
  ds_write_b128 v4, v[72:75] offset:2048
  ds_write_b128 v4, v[76:79] offset:3072
  s_nop 0
  v_add_u32 v4, s41, v3
  ds_write_b128 v4, v[48:51] offset:0
  ds_write_b128 v4, v[52:55] offset:1024
  ds_write_b128 v4, v[56:59] offset:2048
  ds_write_b128 v4, v[60:63] offset:3072
  s_nop 0
  v_add_u32 v4, s40, v3
  ds_write_b128 v4, v[32:35] offset:0
  ds_write_b128 v4, v[36:39] offset:1024
  ds_write_b128 v4, v[40:43] offset:2048
  ds_write_b128 v4, v[44:47] offset:3072
  s_nop 0
  v_add_u32 v4, s43, v3
  s_waitcnt lgkmcnt(0)
  s_barrier
  ds_read_b128 v[80:83], v4 offset:0
  ds_read_b128 v[96:99], v4 offset:4096
  ds_read_b128 v[112:115], v4 offset:8192
  ds_read_b128 v[84:87], v4 offset:1024
  ds_read_b128 v[100:103], v4 offset:5120
  ds_read_b128 v[116:119], v4 offset:9216
  ds_read_b128 v[88:91], v4 offset:2048
  ds_read_b128 v[104:107], v4 offset:6144
  ds_read_b128 v[120:123], v4 offset:10240
  ds_read_b128 v[92:95], v4 offset:3072
  ds_read_b128 v[108:111], v4 offset:7168
  ds_read_b128 v[124:127], v4 offset:11264
  s_waitcnt lgkmcnt(9)
  v_pk_add_f32 v[80:81], v[80:81], v[96:97]
  v_pk_add_f32 v[16:17], v[16:17], v[112:113]
  v_pk_add_f32 v[82:83], v[82:83], v[98:99]
  v_pk_add_f32 v[18:19], v[18:19], v[114:115]
  v_pk_add_f32 v[16:17], v[16:17], v[80:81]
  v_pk_add_f32 v[18:19], v[18:19], v[82:83]
  v_pk_fma_f32 v[208:209], v[16:17], v[176:177], v[208:209]
  v_pk_fma_f32 v[210:211], v[18:19], v[178:179], v[210:211]
  v_cvt_pk_bf16_f32 v192, v208, v209
  v_cvt_pk_bf16_f32 v193, v210, v211
  s_waitcnt lgkmcnt(6)
  v_pk_add_f32 v[84:85], v[84:85], v[100:101]
  v_pk_add_f32 v[20:21], v[20:21], v[116:117]
  v_pk_add_f32 v[86:87], v[86:87], v[102:103]
  v_pk_add_f32 v[22:23], v[22:23], v[118:119]
  v_pk_add_f32 v[20:21], v[20:21], v[84:85]
  v_pk_add_f32 v[22:23], v[22:23], v[86:87]
  v_pk_fma_f32 v[212:213], v[20:21], v[180:181], v[212:213]
  v_pk_fma_f32 v[214:215], v[22:23], v[182:183], v[214:215]
  v_cvt_pk_bf16_f32 v196, v212, v213
  v_cvt_pk_bf16_f32 v197, v214, v215
  s_waitcnt lgkmcnt(3)
  v_pk_add_f32 v[88:89], v[88:89], v[104:105]
  v_pk_add_f32 v[24:25], v[24:25], v[120:121]
  v_pk_add_f32 v[90:91], v[90:91], v[106:107]
  v_pk_add_f32 v[26:27], v[26:27], v[122:123]
  v_pk_add_f32 v[24:25], v[24:25], v[88:89]
  v_pk_add_f32 v[26:27], v[26:27], v[90:91]
  v_pk_fma_f32 v[216:217], v[24:25], v[184:185], v[216:217]
  v_pk_fma_f32 v[218:219], v[26:27], v[186:187], v[218:219]
  v_cvt_pk_bf16_f32 v194, v216, v217
  v_cvt_pk_bf16_f32 v195, v218, v219
  s_nop 0
  v_permlane32_swap_b32 v192, v194
  v_permlane32_swap_b32 v193, v195
  buffer_store_dwordx4 v[192:195], v15, s[12:15], s53 offen offset:0
  s_waitcnt lgkmcnt(0)
  v_pk_add_f32 v[92:93], v[92:93], v[108:109]
  v_pk_add_f32 v[28:29], v[28:29], v[124:125]
  v_pk_add_f32 v[94:95], v[94:95], v[110:111]
  v_pk_add_f32 v[30:31], v[30:31], v[126:127]
  v_pk_add_f32 v[28:29], v[28:29], v[92:93]
  v_pk_add_f32 v[30:31], v[30:31], v[94:95]
  v_pk_fma_f32 v[220:221], v[28:29], v[188:189], v[220:221]
  v_pk_fma_f32 v[222:223], v[30:31], v[190:191], v[222:223]
  v_cvt_pk_bf16_f32 v198, v220, v221
  v_cvt_pk_bf16_f32 v199, v222, v223
  s_nop 0
  v_permlane32_swap_b32 v196, v198
  v_permlane32_swap_b32 v197, v199
  buffer_store_dwordx4 v[196:199], v15, s[12:15], s53 offen offset:16
M_end:
M_exit:
  s_endpgm
B_slow:
  s_mov_b32 s70, 1
  s_lshr_b32 s26, s39, 14
  s_waitcnt vmcnt(0) lgkmcnt(0)
  s_barrier
  s_mov_b32 exec_lo, 0
  v_mov_b32 v22, 0
  v_mov_b32 v23, 0
  v_mov_b32 v30, 0
  v_mov_b32 v31, 0
  v_mov_b32 v38, 0
  v_mov_b32 v39, 0
  v_mov_b32 v46, 0
  v_mov_b32 v47, 0
  s_mov_b64 exec, -1
  v_mov_b32 v232, 0xff800000
  v_mov_b32 v233, 0xff800000
  v_mov_b32 v234, 0xff800000
  v_mov_b32 v235, 0xff800000
  s_mov_b32 s36, 0
  s_mov_b32 s35, 0
B_slow_loop:
  buffer_load_dwordx4 v[96:99], v15, s[20:23], s36 offen sc1
  buffer_load_dwordx4 v[100:103], v15, s[20:23], s36 offen offset:1024 sc1
  s_waitcnt vmcnt(0)
  v_mfma_f32_32x32x16_bf16 v[48:63], v[96:99], v[16:19], 0
  v_mfma_f32_32x32x16_bf16 v[48:63], v[100:103], v[20:23], v[48:63]
  s_nop 11
  v_max3_f32 v232, v232, v48, v49
  v_max3_f32 v232, v232, v50, v51
  v_max3_f32 v232, v232, v52, v53
  v_max3_f32 v232, v232, v54, v55
  v_max3_f32 v232, v232, v56, v57
  v_max3_f32 v232, v232, v58, v59
  v_max3_f32 v232, v232, v60, v61
  v_max3_f32 v232, v232, v62, v63
  v_mfma_f32_32x32x16_bf16 v[48:63], v[96:99], v[24:27], 0
  v_mfma_f32_32x32x16_bf16 v[48:63], v[100:103], v[28:31], v[48:63]
  s_nop 11
  v_max3_f32 v233, v233, v48, v49
  v_max3_f32 v233, v233, v50, v51
  v_max3_f32 v233, v233, v52, v53
  v_max3_f32 v233, v233, v54, v55
  v_max3_f32 v233, v233, v56, v57
  v_max3_f32 v233, v233, v58, v59
  v_max3_f32 v233, v233, v60, v61
  v_max3_f32 v233, v233, v62, v63
  v_mfma_f32_32x32x16_bf16 v[48:63], v[96:99], v[32:35], 0
  v_mfma_f32_32x32x16_bf16 v[48:63], v[100:103], v[36:39], v[48:63]
  s_nop 11
  v_max3_f32 v234, v234, v48, v49
  v_max3_f32 v234, v234, v50, v51
  v_max3_f32 v234, v234, v52, v53
  v_max3_f32 v234, v234, v54, v55
  v_max3_f32 v234, v234, v56, v57
  v_max3_f32 v234, v234, v58, v59
  v_max3_f32 v234, v234, v60, v61
  v_max3_f32 v234, v234, v62, v63
  v_mfma_f32_32x32x16_bf16 v[48:63], v[96:99], v[40:43], 0
  v_mfma_f32_32x32x16_bf16 v[48:63], v[100:103], v[44:47], v[48:63]
  s_nop 11
  v_max3_f32 v235, v235, v48, v49
  v_max3_f32 v235, v235, v50, v51
  v_max3_f32 v235, v235, v52, v53
  v_max3_f32 v235, v235, v54, v55
  v_max3_f32 v235, v235, v56, v57
  v_max3_f32 v235, v235, v58, v59
  v_max3_f32 v235, v235, v60, v61
  v_max3_f32 v235, v235, v62, v63
  s_add_u32 s36, s36, 0x4000
  s_add_u32 s35, s35, 1
  s_cmp_lt_u32 s35, 16
  s_cbranch_scc1 B_slow_loop
  v_lshlrev_b32 v5, 2, v1
  v_add_u32 v5, 94208, v5
  s_lshl_b32 s35, s24, 8
  v_add_u32 v4, s35, v5
  v_mov_b32 v236, v232
  s_nop 1
  v_permlane32_swap_b32 v232, v236
  v_max_f32 v232, v232, v236
  s_add_u32 s36, s24, 0
  s_and_b32 s36, s36, 3
  s_lshl_b32 s44, s36, 10
  v_add_u32 v6, s44, v4
  ds_write_b32 v6, v232
  v_mov_b32 v236, v233
  s_nop 1
  v_permlane32_swap_b32 v233, v236
  v_max_f32 v233, v233, v236
  s_add_u32 s36, s24, 1
  s_and_b32 s36, s36, 3
  s_lshl_b32 s45, s36, 10
  v_add_u32 v6, s45, v4
  ds_write_b32 v6, v233
  v_mov_b32 v236, v234
  s_nop 1
  v_permlane32_swap_b32 v234, v236
  v_max_f32 v234, v234, v236
  s_add_u32 s36, s24, 2
  s_and_b32 s36, s36, 3
  s_lshl_b32 s46, s36, 10
  v_add_u32 v6, s46, v4
  ds_write_b32 v6, v234
  v_mov_b32 v236, v235
  s_nop 1
  v_permlane32_swap_b32 v235, v236
  v_max_f32 v235, v235, v236
  s_add_u32 s36, s24, 3
  s_and_b32 s36, s36, 3
  s_lshl_b32 s47, s36, 10
  v_add_u32 v6, s47, v4
  ds_write_b32 v6, v235
  s_waitcnt lgkmcnt(0)
  s_barrier
  v_add_u32 v6, s44, v5
  ds_read2st64_b32 v[48:49], v6 offset0:0 offset1:1
  ds_read2st64_b32 v[50:51], v6 offset0:2 offset1:3
  v_add_u32 v6, s45, v5
  ds_read2st64_b32 v[52:53], v6 offset0:0 offset1:1
  ds_read2st64_b32 v[54:55], v6 offset0:2 offset1:3
  v_add_u32 v6, s46, v5
  ds_read2st64_b32 v[56:57], v6 offset0:0 offset1:1
  ds_read2st64_b32 v[58:59], v6 offset0:2 offset1:3
  v_add_u32 v6, s47, v5
  ds_read2st64_b32 v[60:61], v6 offset0:0 offset1:1
  ds_read2st64_b32 v[62:63], v6 offset0:2 offset1:3
  s_mov_b32 s36, s39
  buffer_load_dwordx4 v[96:99], v15, s[20:23], s36 offen sc1
  buffer_load_dwordx4 v[100:103], v15, s[20:23], s36 offen offset:1024 sc1
  buffer_load_dwordx4 v[104:107], v15, s[20:23], s36 offen offset:2048 sc1
  buffer_load_dwordx4 v[108:111], v15, s[20:23], s36 offen offset:3072 sc1
  s_waitcnt lgkmcnt(0)
  s_barrier
  s_mov_b32 exec_lo, 0
  v_max3_f32 v232, v48, v49, v50
  v_max_f32 v232, v232, v51
  v_cvt_pk_bf16_f32 v233, -v232, -v232
  v_and_b32 v233, s34, v233
  v_sub_f32 v234, -v232, v233
  v_cvt_pk_bf16_f32 v235, v234, v234
  v_and_b32 v235, s34, v235
  v_sub_f32 v234, v234, v235
  v_cvt_pk_bf16_f32 v22, v233, v235
  v_cvt_pk_bf16_f32 v23, v234, 0
  v_max3_f32 v232, v52, v53, v54
  v_max_f32 v232, v232, v55
  v_cvt_pk_bf16_f32 v233, -v232, -v232
  v_and_b32 v233, s34, v233
  v_sub_f32 v234, -v232, v233
  v_cvt_pk_bf16_f32 v235, v234, v234
  v_and_b32 v235, s34, v235
  v_sub_f32 v234, v234, v235
  v_cvt_pk_bf16_f32 v30, v233, v235
  v_cvt_pk_bf16_f32 v31, v234, 0
  v_max3_f32 v232, v56, v57, v58
  v_max_f32 v232, v232, v59
  v_cvt_pk_bf16_f32 v233, -v232, -v232
  v_and_b32 v233, s34, v233
  v_sub_f32 v234, -v232, v233
  v_cvt_pk_bf16_f32 v235, v234, v234
  v_and_b32 v235, s34, v235
  v_sub_f32 v234, v234, v235
  v_cvt_pk_bf16_f32 v38, v233, v235
  v_cvt_pk_bf16_f32 v39, v234, 0
  v_max3_f32 v232, v60, v61, v62
  v_max_f32 v232, v232, v63
  v_cvt_pk_bf16_f32 v233, -v232, -v232
  v_and_b32 v233, s34, v233
  v_sub_f32 v234, -v232, v233
  v_cvt_pk_bf16_f32 v235, v234, v234
  v_and_b32 v235, s34, v235
  v_sub_f32 v234, v234, v235
  v_cvt_pk_bf16_f32 v46, v233, v235
  v_cvt_pk_bf16_f32 v47, v234, 0
  s_mov_b64 exec, -1
  s_waitcnt vmcnt(0)
  s_nop 0
  v_mfma_f32_32x32x16_bf16 v[48:63], v[96:99], v[16:19], 0
  v_mfma_f32_32x32x16_bf16 v[48:63], v[100:103], v[20:23], v[48:63]
  s_nop 7
  s_nop 7
  s_branch B_restart
mega_end:
.section .rodata,"a"
.p2align 6
.amdhsa_kernel mega_kernel
  .amdhsa_next_free_vgpr 512
  .amdhsa_next_free_sgpr 96
  .amdhsa_accum_offset 256
  .amdhsa_group_segment_fixed_size 0
  .amdhsa_kernarg_size 96
  .amdhsa_user_sgpr_count 2
  .amdhsa_user_sgpr_kernarg_segment_ptr 1
  .amdhsa_system_sgpr_workgroup_id_x 1
.end_amdhsa_kernel
.text
```
